```python
import torch

def _softmax(x, axis=-1):
    return torch.softmax(x, dim=axis)
def _gelu(x):
    return torch.nn.functional.gelu(x, approximate="tanh")
def _silu(x):
    return torch.nn.functional.silu(x)
def _sigmoid(x):
    return torch.sigmoid(x)
def _layernorm(x, axis=-1, eps=1e-5):
    m = x.mean(dim=axis, keepdim=True)
    v = x.var(dim=axis, keepdim=True, unbiased=False)
    return (x - m) / torch.sqrt(v + eps)
def _scatter_add(tgt, idx, src, axis=0):
    return tgt.clone().index_add_(axis, idx, src)
def _segment_sum(src, seg, n):
    out = torch.zeros((n,) + src.shape[1:], dtype=src.dtype)
    return out.index_add_(0, seg, src)
def _pad(x, pw):
    flat = tuple(v for pair in reversed(pw) for v in pair)
    return torch.nn.functional.pad(x, flat)

kernel_name = 'parallel_sum__sliding_block__mixer_channel_mlp__prompt'

def setup_inputs():

    _w = (lambda a: (lambda t: t.to(torch.bfloat16) if t.is_floating_point() else t)(torch.as_tensor(a)))
    def _A_setup():
        B, S, D = 1, 2048, 512
        return {
            "x": _w((lambda *s: torch.randn(*s, dtype=torch.bfloat16) * 0.05)(B, S, D)),
            "wqkv": _w((lambda *s: torch.randn(*s, dtype=torch.bfloat16) * 0.05)(D, 3 * D)),
            "wo": _w((lambda *s: torch.randn(*s, dtype=torch.bfloat16) * 0.05)(D, D)),
        }
    _A_in = _A_setup()

    def _B_setup():
        B, S, D, F = 1, 2048, 512, 1376
        return {
            "x": _w((lambda *s: torch.randn(*s, dtype=torch.bfloat16) * 0.05)(B, S, D)),
            "w1": _w((lambda *s: torch.randn(*s, dtype=torch.bfloat16) * 3.2)(D, F) * (D ** -0.5)),
            "b1": _w((lambda *s: torch.randn(*s, dtype=torch.bfloat16) * 1.6)(F)),
            "w2": _w((lambda *s: torch.randn(*s, dtype=torch.bfloat16) * 0.2)(F, D) * (F ** -0.5)),
            "b2": _w((lambda *s: torch.randn(*s, dtype=torch.bfloat16) * 0.2)(D)),
        }
    _B_in = _B_setup()

    return {
        "A_x": _A_in["x"],
        "A_wqkv": _A_in["wqkv"],
        "A_wo": _A_in["wo"],
        "B_x": _B_in["x"],
        "B_w1": _B_in["w1"],
        "B_b1": _B_in["b1"],
        "B_w2": _B_in["w2"],
        "B_b2": _B_in["b2"],
    }

def reference(A_x, A_wqkv, A_wo, B_x, B_w1, B_b1, B_w2, B_b2):
    def _A_ref(x, wqkv, wo):
        B, S, D = x.shape
        H = 32; Dh = D // H; W = 256
        qkv = (lambda x, *d: x.permute(*d))((x @ wqkv).reshape(B, S, 3, H, Dh), 2, 0, 3, 1, 4)
        q, k, v = qkv[0], qkv[1], qkv[2]
        scores = torch.einsum("bhqd,bhkd->bhqk", q, k) * (Dh ** -0.5)
        idx = torch.arange(S)
        mask = (idx[:, None] - idx[None, :] >= 0) & (idx[:, None] - idx[None, :] < W)
        scores = torch.where(mask[None, None], scores, -1e9)
        p = _softmax(scores, axis=-1)
        o = torch.einsum("bhqk,bhkd->bhqd", p, v)
        return (lambda x, *d: x.permute(*d))(o, 0, 2, 1, 3).reshape(B, S, D) @ wo

    def _B_ref(x, w1, b1, w2, b2):
        y = _layernorm(x, axis=-1)
        h = _gelu(torch.einsum("bsd,df->bsf", y, w1) + b1)
        return torch.einsum("bsf,fd->bsd", h, w2) + b2

    x = A_x
    xn = _layernorm(x, axis=-1)
    return x + _A_ref(xn, A_wqkv, A_wo) + _B_ref(xn, B_w1, B_b1, B_w2, B_b2)
```

```asm
; @launch grid=(256,1,1) block=(512,1,1) lds=160768
.amdgcn_target "amdgcn-amd-amdhsa--gfx950"
.text
.globl parallel_sum__sliding_block__mixer_channel_mlp__prompt_kernel
.p2align 8
.type parallel_sum__sliding_block__mixer_channel_mlp__prompt_kernel,@function
parallel_sum__sliding_block__mixer_channel_mlp__prompt_kernel:
    s_cmp_ge_u32 s2, 256
    s_cbranch_scc1 L_end
    s_load_dwordx16 s[4:19], s[0:1], 0
    s_load_dwordx4 s[20:23], s[0:1], 64
    s_load_dwordx2 s[24:25], s[0:1], 80
    v_lshrrev_b32 v1, 6, v0
    v_and_b32 v0, 63, v0
    v_readfirstlane_b32 s56, v1
    s_and_b32 s66, s2, 7
    s_lshr_b32 s67, s2, 3
    s_lshr_b32 s64, s66, 2
    s_lshl_b32 s64, s64, 3
    s_lshr_b32 s65, s67, 2
    s_add_u32 s58, s64, s65
    s_and_b32 s64, s67, 3
    s_lshl_b32 s60, s64, 1
    s_add_u32 s60, s60, s65
    s_and_b32 s65, s66, 3
    s_lshl_b32 s65, s65, 2
    s_add_u32 s59, s64, s65
    s_and_b32 s60, s60, 7
    s_lshr_b32 s64, s66, 1
    s_lshl_b32 s64, s64, 3
    s_lshr_b32 s65, s67, 2
    s_add_u32 s76, s64, s65
    s_and_b32 s64, s66, 1
    s_lshl_b32 s64, s64, 2
    s_and_b32 s65, s67, 3
    s_add_u32 s77, s64, s65
    s_lshl_b32 s78, s76, 1
    s_and_b32 s57, s56, 3
    s_mul_i32 s68, s59, 192
    s_mul_i32 s69, s59, 3
    s_lshl_b32 s72, s58, 2
    s_add_u32 s72, s72, s57
    s_cmp_lt_u32 s56, 4
    s_cbranch_scc1 L_A
    v_lshrrev_b32 v5, 3, v0
    v_lshrrev_b32 v6, 4, v0
    v_and_b32 v7, 7, v0
    v_xor_b32 v7, v7, v6
    v_lshlrev_b32 v7, 4, v7
    s_lshl_b32 s64, s72, 5
    v_add_u32 v4, s64, v5
    v_lshl_add_u32 v16, v4, 10, v7
    v_xor_b32 v17, 64, v16
    v_add_u32 v18, 14336, v16
    v_add_u32 v19, 21504, v17
    v_add_u32 v17, 7168, v17
    s_lshl_b32 s71, s57, 12
    s_mul_i32 s70, s57, 3072
    s_lshl_b32 s64, s57, 4
    v_add_u32 v4, 0, v0
    v_mul_u32_u24 v5, 43691, v4
    v_lshrrev_b32 v5, 19, v5
    v_mul_u32_u24 v6, 12, v5
    v_sub_u32 v4, v4, v6
    v_add_u32 v5, s64, v5
    v_lshlrev_b32 v4, 4, v4
    v_add_u32 v4, s68, v4
    v_mul_u32_u24 v6, 3072, v5
    v_add_u32 v20, v6, v4
    v_mul_u32_u24 v6, 2752, v5
    v_add_u32 v124, v6, v4
    v_add_u32 v4, 64, v0
    v_mul_u32_u24 v5, 43691, v4
    v_lshrrev_b32 v5, 19, v5
    v_mul_u32_u24 v6, 12, v5
    v_sub_u32 v4, v4, v6
    v_add_u32 v5, s64, v5
    v_lshlrev_b32 v4, 4, v4
    v_add_u32 v4, s68, v4
    v_add_u32 v4, 4294966272, v4
    v_mul_u32_u24 v6, 3072, v5
    v_add_u32 v21, v6, v4
    v_mul_u32_u24 v6, 2752, v5
    v_add_u32 v125, v6, v4
    v_add_u32 v4, 128, v0
    v_mul_u32_u24 v5, 43691, v4
    v_lshrrev_b32 v5, 19, v5
    v_mul_u32_u24 v6, 12, v5
    v_sub_u32 v4, v4, v6
    v_add_u32 v5, s64, v5
    v_lshlrev_b32 v4, 4, v4
    v_add_u32 v4, s68, v4
    v_add_u32 v4, 4294965248, v4
    v_mul_u32_u24 v6, 3072, v5
    v_add_u32 v22, v6, v4
    v_mul_u32_u24 v6, 2752, v5
    v_add_u32 v126, v6, v4
    s_waitcnt lgkmcnt(0)
    s_mov_b32 s28, s4
    s_mov_b32 s29, s5
    s_mov_b32 s30, 2097152
    s_mov_b32 s31, 0x20000
    s_mov_b32 s36, s6
    s_mov_b32 s37, s7
    s_mov_b32 s38, 1572864
    s_mov_b32 s39, 0x20000
    s_add_u32 s63, s60, 0
    s_and_b32 s63, s63, 7
    s_add_u32 m0, s71, 0
    s_lshl_b32 s62, s63, 7
    buffer_load_dwordx4 v16, s[28:31], s62 offen offset:0 lds
    buffer_load_dwordx4 v17, s[28:31], s62 offen offset:1024 lds
    buffer_load_dwordx4 v18, s[28:31], s62 offen offset:2048 lds
    buffer_load_dwordx4 v19, s[28:31], s62 offen offset:3072 lds
    s_add_u32 m0, s70, 65536
    s_mul_i32 s62, s63, 196608
    buffer_load_dwordx4 v20, s[36:39], s62 offen offset:0 lds
    buffer_load_dwordx4 v21, s[36:39], s62 offen offset:1024 lds
    buffer_load_dwordx4 v22, s[36:39], s62 offen offset:2048 lds
    s_add_u32 s66, s24, 458752
    s_addc_u32 s67, s25, 0
    s_load_dword s61, s[66:67], 0
    s_mov_b32 s32, s24
    s_mov_b32 s33, s25
    s_mov_b32 s34, 268435456
    s_mov_b32 s35, 0x20000
    s_mov_b32 s44, s12
    s_mov_b32 s45, s13
    s_mov_b32 s46, 1409024
    s_mov_b32 s47, 0x20000
    s_cmp_lt_u32 s69, 43
    s_cselect_b32 s46, s46, 0
    v_mov_b32 v6, 0
    v_lshlrev_b32 v7, 2, v0
    v_and_b32 v7, 127, v7
    v_add_u32 v7, 150528, v7
    ds_write_b32 v7, v6
    v_lshrrev_b32 v4, 5, v0
    v_lshlrev_b32 v4, 3, v4
    v_bfe_u32 v5, v0, 2, 2
    v_add_u32 v4, v4, v5
    v_mul_u32_u24 v5, 192, v4
    v_bfe_u32 v4, v0, 4, 1
    v_lshl_add_u32 v5, v4, 5, v5
    v_and_b32 v4, 3, v0
    v_lshl_add_u32 v5, v4, 3, v5
    v_and_b32 v6, 31, v0
    v_lshlrev_b32 v6, 7, v6
    s_lshl_b32 s64, s57, 12
    v_add_u32 v6, s64, v6
    v_lshrrev_b32 v4, 5, v0
    v_bfe_u32 v7, v0, 1, 3
    v_xor_b32 v7, v7, v4
    s_xor_b32 s65, s57, 0
    s_lshl_b32 s64, s65, 1
    v_xor_b32 v4, s64, v7
    v_lshl_add_u32 v24, v4, 4, v6
    s_mul_i32 s64, s65, 3072
    s_add_u32 s64, s64, 0
    v_add_u32 v100, s64, v5
    s_xor_b32 s65, s57, 1
    s_lshl_b32 s64, s65, 1
    v_xor_b32 v4, s64, v7
    v_lshl_add_u32 v25, v4, 4, v6
    s_mul_i32 s64, s65, 3072
    s_add_u32 s64, s64, 0
    v_add_u32 v101, s64, v5
    s_xor_b32 s65, s57, 2
    s_lshl_b32 s64, s65, 1
    v_xor_b32 v4, s64, v7
    v_lshl_add_u32 v26, v4, 4, v6
    s_mul_i32 s64, s65, 3072
    s_add_u32 s64, s64, 0
    v_add_u32 v102, s64, v5
    s_xor_b32 s65, s57, 3
    s_lshl_b32 s64, s65, 1
    v_xor_b32 v4, s64, v7
    v_lshl_add_u32 v27, v4, 4, v6
    s_mul_i32 s64, s65, 3072
    s_add_u32 s64, s64, 0
    v_add_u32 v103, s64, v5
    v_add_u32 v104, 65536, v100
    v_add_u32 v105, 65536, v101
    v_add_u32 v106, 65536, v102
    v_add_u32 v107, 65536, v103
    v_bfe_u32 v5, v0, 4, 1
    v_and_b32 v7, 15, v0
    v_cmp_eq_u32 vcc, v5, v7
    v_mov_b32 v5, 0x3f803f80
    s_nop 0
    v_cndmask_b32 v120, 0, v5, vcc
    v_mov_b32 v121, v120
    v_mov_b32 v122, v120
    v_mov_b32 v123, v120
    s_mul_i32 s64, s57, 768
    s_add_u32 s64, s64, 147840
    v_lshlrev_b32 v14, 2, v0
    v_and_b32 v15, 124, v14
    v_add_u32 v14, s64, v14
    v_add_u32 v15, 147840, v15
    v_mov_b32 v12, 150528
    v_mov_b32 v13, 1
    s_mov_b32 s48, s14
    s_mov_b32 s49, s15
    s_mov_b32 s50, 2752
    s_mov_b32 s51, 0x20000
    v_and_b32 v4, 31, v0
    v_lshlrev_b32 v4, 1, v4
    s_lshl_b32 s64, s69, 6
    v_add_u32 v4, s64, v4
    v_mov_b32 v8, 0
    v_mov_b32 v9, 0
    v_mov_b32 v10, 0
    buffer_load_short_d16_hi v8, v4, s[48:51], 0 offen offset:0
    buffer_load_short_d16_hi v9, v4, s[48:51], 0 offen offset:64
    buffer_load_short_d16_hi v10, v4, s[48:51], 0 offen offset:128
    s_add_u32 s63, s60, 1
    s_and_b32 s63, s63, 7
    s_add_u32 m0, s71, 16384
    s_lshl_b32 s62, s63, 7
    buffer_load_dwordx4 v16, s[28:31], s62 offen offset:0 lds
    buffer_load_dwordx4 v17, s[28:31], s62 offen offset:1024 lds
    buffer_load_dwordx4 v18, s[28:31], s62 offen offset:2048 lds
    buffer_load_dwordx4 v19, s[28:31], s62 offen offset:3072 lds
    s_add_u32 m0, s70, 77824
    s_mul_i32 s62, s63, 196608
    buffer_load_dwordx4 v20, s[36:39], s62 offen offset:0 lds
    buffer_load_dwordx4 v21, s[36:39], s62 offen offset:1024 lds
    buffer_load_dwordx4 v22, s[36:39], s62 offen offset:2048 lds
    s_waitcnt lgkmcnt(0)
    s_mul_i32 s61, s61, 0x9e3779b1
    s_add_u32 s61, s61, 0x7f4a7c15
    s_waitcnt vmcnt(10)
    s_barrier
    ds_read_b128 v[128:131], v24 offset:0
    ds_read_b128 v[132:135], v25 offset:0
    ds_read_b128 v[136:139], v26 offset:0
    ds_read_b128 v[140:143], v27 offset:0
    s_add_u32 s63, s60, 2
    s_and_b32 s63, s63, 7
    s_add_u32 m0, s71, 32768
    s_lshl_b32 s62, s63, 7
    buffer_load_dwordx4 v16, s[28:31], s62 offen offset:0 lds
    buffer_load_dwordx4 v17, s[28:31], s62 offen offset:1024 lds
    buffer_load_dwordx4 v18, s[28:31], s62 offen offset:2048 lds
    buffer_load_dwordx4 v19, s[28:31], s62 offen offset:3072 lds
    s_add_u32 m0, s70, 90112
    s_mul_i32 s62, s63, 196608
    buffer_load_dwordx4 v20, s[36:39], s62 offen offset:0 lds
    buffer_load_dwordx4 v21, s[36:39], s62 offen offset:1024 lds
    buffer_load_dwordx4 v22, s[36:39], s62 offen offset:2048 lds
    s_waitcnt lgkmcnt(0)
    s_waitcnt vmcnt(7)
    s_barrier
    ds_read_b128 v[144:147], v24 offset:16384
    ds_read_b128 v[148:151], v25 offset:16384
    ds_read_b128 v[152:155], v26 offset:16384
    ds_read_b128 v[156:159], v27 offset:16384
    s_add_u32 s63, s60, 3
    s_and_b32 s63, s63, 7
    s_add_u32 m0, s71, 49152
    s_lshl_b32 s62, s63, 7
    buffer_load_dwordx4 v16, s[28:31], s62 offen offset:0 lds
    buffer_load_dwordx4 v17, s[28:31], s62 offen offset:1024 lds
    buffer_load_dwordx4 v18, s[28:31], s62 offen offset:2048 lds
    buffer_load_dwordx4 v19, s[28:31], s62 offen offset:3072 lds
    s_add_u32 m0, s70, 102400
    s_mul_i32 s62, s63, 196608
    buffer_load_dwordx4 v20, s[36:39], s62 offen offset:0 lds
    buffer_load_dwordx4 v21, s[36:39], s62 offen offset:1024 lds
    buffer_load_dwordx4 v22, s[36:39], s62 offen offset:2048 lds
    s_waitcnt lgkmcnt(0)
    s_waitcnt vmcnt(7)
    s_barrier
    ds_read_b128 v[160:163], v24 offset:32768
    ds_read_b128 v[164:167], v25 offset:32768
    ds_read_b128 v[168:171], v26 offset:32768
    ds_read_b128 v[172:175], v27 offset:32768
    s_add_u32 s63, s60, 4
    s_and_b32 s63, s63, 7
    s_add_u32 m0, s71, 0
    s_lshl_b32 s62, s63, 7
    buffer_load_dwordx4 v16, s[28:31], s62 offen offset:0 lds
    buffer_load_dwordx4 v17, s[28:31], s62 offen offset:1024 lds
    buffer_load_dwordx4 v18, s[28:31], s62 offen offset:2048 lds
    buffer_load_dwordx4 v19, s[28:31], s62 offen offset:3072 lds
    s_add_u32 m0, s70, 65536
    s_mul_i32 s62, s63, 196608
    buffer_load_dwordx4 v20, s[36:39], s62 offen offset:0 lds
    buffer_load_dwordx4 v21, s[36:39], s62 offen offset:1024 lds
    buffer_load_dwordx4 v22, s[36:39], s62 offen offset:2048 lds
    s_waitcnt lgkmcnt(0)
    s_waitcnt vmcnt(7)
    s_barrier
    ds_read_b128 v[176:179], v24 offset:49152
    ds_read_b128 v[180:183], v25 offset:49152
    ds_read_b128 v[184:187], v26 offset:49152
    ds_read_b128 v[188:191], v27 offset:49152
    s_add_u32 s63, s60, 5
    s_and_b32 s63, s63, 7
    s_add_u32 m0, s71, 16384
    s_lshl_b32 s62, s63, 7
    buffer_load_dwordx4 v16, s[28:31], s62 offen offset:0 lds
    buffer_load_dwordx4 v17, s[28:31], s62 offen offset:1024 lds
    buffer_load_dwordx4 v18, s[28:31], s62 offen offset:2048 lds
    buffer_load_dwordx4 v19, s[28:31], s62 offen offset:3072 lds
    s_add_u32 m0, s70, 77824
    s_mul_i32 s62, s63, 196608
    buffer_load_dwordx4 v20, s[36:39], s62 offen offset:0 lds
    buffer_load_dwordx4 v21, s[36:39], s62 offen offset:1024 lds
    buffer_load_dwordx4 v22, s[36:39], s62 offen offset:2048 lds
    s_waitcnt lgkmcnt(0)
    s_waitcnt vmcnt(7)
    s_barrier
    ds_read_b128 v[192:195], v24 offset:0
    ds_read_b128 v[196:199], v25 offset:0
    ds_read_b128 v[200:203], v26 offset:0
    ds_read_b128 v[204:207], v27 offset:0
    s_add_u32 s63, s60, 6
    s_and_b32 s63, s63, 7
    s_add_u32 m0, s71, 32768
    s_lshl_b32 s62, s63, 7
    buffer_load_dwordx4 v16, s[28:31], s62 offen offset:0 lds
    buffer_load_dwordx4 v17, s[28:31], s62 offen offset:1024 lds
    buffer_load_dwordx4 v18, s[28:31], s62 offen offset:2048 lds
    buffer_load_dwordx4 v19, s[28:31], s62 offen offset:3072 lds
    s_add_u32 m0, s70, 90112
    s_mul_i32 s62, s63, 196608
    buffer_load_dwordx4 v20, s[36:39], s62 offen offset:0 lds
    buffer_load_dwordx4 v21, s[36:39], s62 offen offset:1024 lds
    buffer_load_dwordx4 v22, s[36:39], s62 offen offset:2048 lds
    v_and_b32 v11, 31, v0
    s_lshl_b32 s64, s72, 5
    v_add_u32 v11, s64, v11
    v_lshlrev_b32 v11, 4, v11
    v_add_u32 v11, 393216, v11
    buffer_load_dwordx4 v[4:7], v11, s[32:35], 0 offen sc1
    s_waitcnt lgkmcnt(0)
    s_waitcnt vmcnt(8)
    s_barrier
    ds_read_b128 v[208:211], v24 offset:16384
    ds_read_b128 v[212:215], v25 offset:16384
    ds_read_b128 v[216:219], v26 offset:16384
    ds_read_b128 v[220:223], v27 offset:16384
    s_add_u32 s63, s60, 7
    s_and_b32 s63, s63, 7
    s_add_u32 m0, s71, 49152
    s_lshl_b32 s62, s63, 7
    buffer_load_dwordx4 v16, s[28:31], s62 offen offset:0 lds
    buffer_load_dwordx4 v17, s[28:31], s62 offen offset:1024 lds
    buffer_load_dwordx4 v18, s[28:31], s62 offen offset:2048 lds
    buffer_load_dwordx4 v19, s[28:31], s62 offen offset:3072 lds
    s_add_u32 m0, s70, 102400
    s_mul_i32 s62, s63, 196608
    buffer_load_dwordx4 v20, s[36:39], s62 offen offset:0 lds
    buffer_load_dwordx4 v21, s[36:39], s62 offen offset:1024 lds
    buffer_load_dwordx4 v22, s[36:39], s62 offen offset:2048 lds
    s_waitcnt lgkmcnt(0)
    s_waitcnt vmcnt(8)
    s_barrier
    ds_read_b128 v[224:227], v24 offset:32768
    ds_read_b128 v[228:231], v25 offset:32768
    ds_read_b128 v[232:235], v26 offset:32768
    ds_read_b128 v[236:239], v27 offset:32768
    s_add_u32 s63, s60, 0
    s_and_b32 s63, s63, 7
    s_add_u32 m0, s70, 65536
    s_mul_i32 s62, s63, 176128
    buffer_load_dwordx4 v124, s[44:47], s62 offen offset:0 lds
    buffer_load_dwordx4 v125, s[44:47], s62 offen offset:1024 lds
    buffer_load_dwordx4 v126, s[44:47], s62 offen offset:2048 lds
    s_add_u32 s63, s60, 1
    s_and_b32 s63, s63, 7
    s_add_u32 m0, s70, 0
    s_mul_i32 s62, s63, 176128
    buffer_load_dwordx4 v124, s[44:47], s62 offen offset:0 lds
    buffer_load_dwordx4 v125, s[44:47], s62 offen offset:1024 lds
    buffer_load_dwordx4 v126, s[44:47], s62 offen offset:2048 lds
    s_waitcnt lgkmcnt(0)
    s_waitcnt vmcnt(6)
    s_barrier
    ds_read_b128 v[240:243], v24 offset:49152
    ds_read_b128 v[244:247], v25 offset:49152
    ds_read_b128 v[248:251], v26 offset:49152
    ds_read_b128 v[252:255], v27 offset:49152
    s_add_u32 s63, s60, 2
    s_and_b32 s63, s63, 7
    s_add_u32 m0, s70, 77824
    s_mul_i32 s62, s63, 176128
    buffer_load_dwordx4 v124, s[44:47], s62 offen offset:0 lds
    buffer_load_dwordx4 v125, s[44:47], s62 offen offset:1024 lds
    buffer_load_dwordx4 v126, s[44:47], s62 offen offset:2048 lds
    s_add_u32 s63, s60, 3
    s_and_b32 s63, s63, 7
    s_add_u32 m0, s70, 16384
    s_mul_i32 s62, s63, 176128
    buffer_load_dwordx4 v124, s[44:47], s62 offen offset:0 lds
    buffer_load_dwordx4 v125, s[44:47], s62 offen offset:1024 lds
    buffer_load_dwordx4 v126, s[44:47], s62 offen offset:2048 lds
    s_waitcnt lgkmcnt(0)
    s_waitcnt vmcnt(6)
    s_barrier
    ds_read_b64_tr_b16 v[64:65], v104 offset:0
    ds_read_b64_tr_b16 v[66:67], v104 offset:768
    ds_read_b64_tr_b16 v[68:69], v104 offset:64
    ds_read_b64_tr_b16 v[70:71], v104 offset:832
    ds_read_b64_tr_b16 v[72:73], v104 offset:128
    ds_read_b64_tr_b16 v[74:75], v104 offset:896
    ds_read_b64_tr_b16 v[76:77], v105 offset:0
    ds_read_b64_tr_b16 v[78:79], v105 offset:768
    ds_read_b64_tr_b16 v[80:81], v105 offset:64
    ds_read_b64_tr_b16 v[82:83], v105 offset:832
    ds_read_b64_tr_b16 v[84:85], v105 offset:128
    ds_read_b64_tr_b16 v[86:87], v105 offset:896
    s_waitcnt lgkmcnt(6)
    v_mfma_f32_32x32x16_bf16 v[16:31], v[64:67], v[128:131], 0
    ds_read_b64_tr_b16 v[88:89], v106 offset:0
    ds_read_b64_tr_b16 v[90:91], v106 offset:768
    v_mfma_f32_16x16x32_bf16 v[108:111], v[120:123], v[64:67], 0
    s_add_u32 s63, s60, 4
    s_and_b32 s63, s63, 7
    s_add_u32 m0, s70, 90112
    s_mul_i32 s62, s63, 176128
    buffer_load_dwordx4 v124, s[44:47], s62 offen offset:0 lds
    v_mfma_f32_32x32x16_bf16 v[32:47], v[68:71], v[128:131], 0
    ds_read_b64_tr_b16 v[92:93], v106 offset:64
    ds_read_b64_tr_b16 v[94:95], v106 offset:832
    v_mfma_f32_16x16x32_bf16 v[112:115], v[120:123], v[68:71], 0
    buffer_load_dwordx4 v125, s[44:47], s62 offen offset:1024 lds
    v_mfma_f32_32x32x16_bf16 v[48:63], v[72:75], v[128:131], 0
    ds_read_b64_tr_b16 v[96:97], v106 offset:128
    ds_read_b64_tr_b16 v[98:99], v106 offset:896
    v_mfma_f32_16x16x32_bf16 v[116:119], v[120:123], v[72:75], 0
    s_waitcnt lgkmcnt(6)
    v_mfma_f32_32x32x16_bf16 v[16:31], v[76:79], v[132:135], v[16:31]
    ds_read_b64_tr_b16 v[64:65], v107 offset:0
    ds_read_b64_tr_b16 v[66:67], v107 offset:768
    buffer_load_dwordx4 v126, s[44:47], s62 offen offset:2048 lds
    v_mfma_f32_32x32x16_bf16 v[32:47], v[80:83], v[132:135], v[32:47]
    ds_read_b64_tr_b16 v[68:69], v107 offset:64
    ds_read_b64_tr_b16 v[70:71], v107 offset:832
    s_add_u32 s63, s60, 5
    s_and_b32 s63, s63, 7
    s_add_u32 m0, s70, 32768
    s_mul_i32 s62, s63, 176128
    buffer_load_dwordx4 v124, s[44:47], s62 offen offset:0 lds
    v_mfma_f32_32x32x16_bf16 v[48:63], v[84:87], v[132:135], v[48:63]
    ds_read_b64_tr_b16 v[72:73], v107 offset:128
    ds_read_b64_tr_b16 v[74:75], v107 offset:896
    s_waitcnt lgkmcnt(6)
    v_mfma_f32_32x32x16_bf16 v[16:31], v[88:91], v[136:139], v[16:31]
    ds_read_b64_tr_b16 v[76:77], v100 offset:0
    ds_read_b64_tr_b16 v[78:79], v100 offset:768
    buffer_load_dwordx4 v125, s[44:47], s62 offen offset:1024 lds
    v_lshrrev_b32 v132, 3, v0
    v_bfe_u32 v133, v0, 4, 1
    v_mfma_f32_32x32x16_bf16 v[32:47], v[92:95], v[136:139], v[32:47]
    ds_read_b64_tr_b16 v[80:81], v100 offset:64
    ds_read_b64_tr_b16 v[82:83], v100 offset:832
    buffer_load_dwordx4 v126, s[44:47], s62 offen offset:2048 lds
    v_lshlrev_b32 v133, 2, v133
    v_and_b32 v134, 7, v0
    v_mfma_f32_32x32x16_bf16 v[48:63], v[96:99], v[136:139], v[48:63]
    ds_read_b64_tr_b16 v[84:85], v100 offset:128
    ds_read_b64_tr_b16 v[86:87], v100 offset:896
    v_xor_b32 v134, v134, v133
    v_lshlrev_b32 v134, 4, v134
    s_waitcnt vmcnt(6)
    s_mov_b64 exec, 1
    ds_add_u32 v12, v13 offset:4
    s_mov_b64 exec, -1
    s_waitcnt lgkmcnt(7)
    v_mfma_f32_32x32x16_bf16 v[16:31], v[64:67], v[140:143], v[16:31]
    ds_read_b64_tr_b16 v[88:89], v101 offset:0
    ds_read_b64_tr_b16 v[90:91], v101 offset:768
    s_add_u32 s63, s60, 6
    s_and_b32 s63, s63, 7
    s_add_u32 m0, s70, 102400
    s_mul_i32 s62, s63, 176128
    buffer_load_dwordx4 v124, s[44:47], s62 offen offset:0 lds
    v_lshl_add_u32 v128, v132, 10, v134
    s_lshl_b32 s79, s77, 7
    v_mfma_f32_32x32x16_bf16 v[32:47], v[68:71], v[140:143], v[32:47]
    ds_read_b64_tr_b16 v[92:93], v101 offset:64
    ds_read_b64_tr_b16 v[94:95], v101 offset:832
    buffer_load_dwordx4 v125, s[44:47], s62 offen offset:1024 lds
    v_add_u32 v128, s79, v128
    v_add_u32 v129, 7168, v128
    v_mfma_f32_32x32x16_bf16 v[48:63], v[72:75], v[140:143], v[48:63]
    ds_read_b64_tr_b16 v[96:97], v101 offset:128
    ds_read_b64_tr_b16 v[98:99], v101 offset:896
    s_mul_i32 s26, s57, 360448
    s_lshl_b32 s27, s57, 11
    s_waitcnt lgkmcnt(7)
    v_mfma_f32_32x32x16_bf16 v[16:31], v[76:79], v[144:147], v[16:31]
    ds_read_b64_tr_b16 v[64:65], v102 offset:0
    ds_read_b64_tr_b16 v[66:67], v102 offset:768
    v_mfma_f32_16x16x32_bf16 v[108:111], v[120:123], v[76:79], v[108:111]
    buffer_load_dwordx4 v126, s[44:47], s62 offen offset:2048 lds
    s_mov_b32 s28, s16
    s_mov_b32 s29, s17
    v_mfma_f32_32x32x16_bf16 v[32:47], v[80:83], v[144:147], v[32:47]
    ds_read_b64_tr_b16 v[68:69], v102 offset:64
    ds_read_b64_tr_b16 v[70:71], v102 offset:832
    v_mfma_f32_16x16x32_bf16 v[112:115], v[120:123], v[80:83], v[112:115]
    s_add_u32 s63, s60, 7
    s_and_b32 s63, s63, 7
    s_add_u32 m0, s70, 49152
    s_mul_i32 s62, s63, 176128
    buffer_load_dwordx4 v124, s[44:47], s62 offen offset:0 lds
    s_mov_b32 s30, 1409024
    s_mov_b32 s31, 0x20000
    v_mfma_f32_32x32x16_bf16 v[48:63], v[84:87], v[144:147], v[48:63]
    ds_read_b64_tr_b16 v[72:73], v102 offset:128
    ds_read_b64_tr_b16 v[74:75], v102 offset:896
    v_mfma_f32_16x16x32_bf16 v[116:119], v[120:123], v[84:87], v[116:119]
    s_mov_b32 s36, s8
    s_mov_b32 s37, s9
    ds_read_b32 v3, v12 offset:4
    s_waitcnt lgkmcnt(7)
    v_mfma_f32_32x32x16_bf16 v[16:31], v[88:91], v[148:151], v[16:31]
    ds_read_b64_tr_b16 v[76:77], v103 offset:0
    ds_read_b64_tr_b16 v[78:79], v103 offset:768
    buffer_load_dwordx4 v125, s[44:47], s62 offen offset:1024 lds
    s_mov_b32 s38, 524288
    s_mov_b32 s39, 0x20000
    v_mfma_f32_32x32x16_bf16 v[32:47], v[92:95], v[148:151], v[32:47]
    ds_read_b64_tr_b16 v[80:81], v103 offset:64
    ds_read_b64_tr_b16 v[82:83], v103 offset:832
    buffer_load_dwordx4 v126, s[44:47], s62 offen offset:2048 lds
    v_mfma_f32_32x32x16_bf16 v[48:63], v[96:99], v[148:151], v[48:63]
    ds_read_b64_tr_b16 v[84:85], v103 offset:128
    ds_read_b64_tr_b16 v[86:87], v103 offset:896
    s_waitcnt lgkmcnt(6)
    v_readfirstlane_b32 s67, v3
    s_cmp_ge_u32 s67, 4
    s_cbranch_scc1 L_syok_1001
    s_mov_b32 s66, 0
L_spin_1002:
    ds_read_b32 v3, v12 offset:4
    s_add_u32 s66, s66, 1
    s_cmp_gt_u32 s66, 400000
    s_cbranch_scc1 L_spinx_1003
    s_waitcnt lgkmcnt(0)
    v_readfirstlane_b32 s67, v3
    s_cmp_ge_u32 s67, 4
    s_cbranch_scc1 L_spinx_1003
    s_branch L_spin_1002
L_spinx_1003:
    s_waitcnt lgkmcnt(0)
L_syok_1001:
    v_mfma_f32_32x32x16_bf16 v[16:31], v[64:67], v[152:155], v[16:31]
    ds_read_b64_tr_b16 v[88:89], v104 offset:12288
    ds_read_b64_tr_b16 v[90:91], v104 offset:13056
    v_mfma_f32_32x32x16_bf16 v[32:47], v[68:71], v[152:155], v[32:47]
    ds_read_b64_tr_b16 v[92:93], v104 offset:12352
    ds_read_b64_tr_b16 v[94:95], v104 offset:13120
    v_mfma_f32_32x32x16_bf16 v[48:63], v[72:75], v[152:155], v[48:63]
    ds_read_b64_tr_b16 v[96:97], v104 offset:12416
    ds_read_b64_tr_b16 v[98:99], v104 offset:13184
    s_and_b32 s64, s76, 7
    s_mul_i32 s64, s64, 236
    s_mul_i32 s65, s57, 59
    s_add_u32 s64, s64, s65
    v_min_u32 v2, 58, v0
    v_add_u32 v2, s64, v2
    v_lshlrev_b32 v2, 10, v2
    s_lshl_b32 s64, s77, 7
    v_add_u32 v2, s64, v2
    v_add_u32 v3, 4294443008, v2
    buffer_load_dword v1, v2, s[36:39], 0 offen
    buffer_load_dword v1, v3, s[28:31], 0 offen
    s_waitcnt lgkmcnt(6)
    v_mfma_f32_32x32x16_bf16 v[16:31], v[76:79], v[156:159], v[16:31]
    ds_read_b64_tr_b16 v[64:65], v105 offset:12288
    ds_read_b64_tr_b16 v[66:67], v105 offset:13056
    v_mfma_f32_32x32x16_bf16 v[32:47], v[80:83], v[156:159], v[32:47]
    ds_read_b64_tr_b16 v[68:69], v105 offset:12352
    ds_read_b64_tr_b16 v[70:71], v105 offset:13120
    v_mfma_f32_32x32x16_bf16 v[48:63], v[84:87], v[156:159], v[48:63]
    ds_read_b64_tr_b16 v[72:73], v105 offset:12416
    ds_read_b64_tr_b16 v[74:75], v105 offset:13184
    s_setprio 3
    s_waitcnt lgkmcnt(6)
    v_mfma_f32_32x32x16_bf16 v[16:31], v[88:91], v[160:163], v[16:31]
    ds_read_b64_tr_b16 v[76:77], v106 offset:12288
    ds_read_b64_tr_b16 v[78:79], v106 offset:13056
    v_mfma_f32_16x16x32_bf16 v[108:111], v[120:123], v[88:91], v[108:111]
    v_mfma_f32_32x32x16_bf16 v[32:47], v[92:95], v[160:163], v[32:47]
    ds_read_b64_tr_b16 v[80:81], v106 offset:12352
    ds_read_b64_tr_b16 v[82:83], v106 offset:13120
    v_mfma_f32_16x16x32_bf16 v[112:115], v[120:123], v[92:95], v[112:115]
    v_mfma_f32_32x32x16_bf16 v[48:63], v[96:99], v[160:163], v[48:63]
    ds_read_b64_tr_b16 v[84:85], v106 offset:12416
    ds_read_b64_tr_b16 v[86:87], v106 offset:13184
    v_mfma_f32_16x16x32_bf16 v[116:119], v[120:123], v[96:99], v[116:119]
    s_waitcnt lgkmcnt(6)
    v_mfma_f32_32x32x16_bf16 v[16:31], v[64:67], v[164:167], v[16:31]
    ds_read_b64_tr_b16 v[88:89], v107 offset:12288
    ds_read_b64_tr_b16 v[90:91], v107 offset:13056
    v_mfma_f32_32x32x16_bf16 v[32:47], v[68:71], v[164:167], v[32:47]
    ds_read_b64_tr_b16 v[92:93], v107 offset:12352
    ds_read_b64_tr_b16 v[94:95], v107 offset:13120
    v_mfma_f32_32x32x16_bf16 v[48:63], v[72:75], v[164:167], v[48:63]
    ds_read_b64_tr_b16 v[96:97], v107 offset:12416
    ds_read_b64_tr_b16 v[98:99], v107 offset:13184
    s_waitcnt vmcnt(8)
    s_mov_b64 exec, 1
    ds_add_u32 v12, v13 offset:8
    s_mov_b64 exec, -1
    s_waitcnt lgkmcnt(7)
    v_mfma_f32_32x32x16_bf16 v[16:31], v[76:79], v[168:171], v[16:31]
    ds_read_b64_tr_b16 v[64:65], v100 offset:16384
    ds_read_b64_tr_b16 v[66:67], v100 offset:17152
    v_mfma_f32_32x32x16_bf16 v[32:47], v[80:83], v[168:171], v[32:47]
    ds_read_b64_tr_b16 v[68:69], v100 offset:16448
    ds_read_b64_tr_b16 v[70:71], v100 offset:17216
    v_mfma_f32_32x32x16_bf16 v[48:63], v[84:87], v[168:171], v[48:63]
    ds_read_b64_tr_b16 v[72:73], v100 offset:16512
    ds_read_b64_tr_b16 v[74:75], v100 offset:17280
    s_waitcnt lgkmcnt(7)
    v_mfma_f32_32x32x16_bf16 v[16:31], v[88:91], v[172:175], v[16:31]
    ds_read_b64_tr_b16 v[76:77], v101 offset:16384
    ds_read_b64_tr_b16 v[78:79], v101 offset:17152
    v_mfma_f32_32x32x16_bf16 v[32:47], v[92:95], v[172:175], v[32:47]
    ds_read_b64_tr_b16 v[80:81], v101 offset:16448
    ds_read_b64_tr_b16 v[82:83], v101 offset:17216
    v_mfma_f32_32x32x16_bf16 v[48:63], v[96:99], v[172:175], v[48:63]
    ds_read_b64_tr_b16 v[84:85], v101 offset:16512
    ds_read_b64_tr_b16 v[86:87], v101 offset:17280
    s_waitcnt lgkmcnt(6)
    v_mfma_f32_32x32x16_bf16 v[16:31], v[64:67], v[176:179], v[16:31]
    ds_read_b64_tr_b16 v[88:89], v102 offset:16384
    ds_read_b64_tr_b16 v[90:91], v102 offset:17152
    v_mfma_f32_16x16x32_bf16 v[108:111], v[120:123], v[64:67], v[108:111]
    v_mfma_f32_32x32x16_bf16 v[32:47], v[68:71], v[176:179], v[32:47]
    ds_read_b64_tr_b16 v[92:93], v102 offset:16448
    ds_read_b64_tr_b16 v[94:95], v102 offset:17216
    v_mfma_f32_16x16x32_bf16 v[112:115], v[120:123], v[68:71], v[112:115]
    v_mfma_f32_32x32x16_bf16 v[48:63], v[72:75], v[176:179], v[48:63]
    ds_read_b64_tr_b16 v[96:97], v102 offset:16512
    ds_read_b64_tr_b16 v[98:99], v102 offset:17280
    v_mfma_f32_16x16x32_bf16 v[116:119], v[120:123], v[72:75], v[116:119]
    ds_read_b32 v3, v12 offset:8
    s_waitcnt lgkmcnt(7)
    v_mfma_f32_32x32x16_bf16 v[16:31], v[76:79], v[180:183], v[16:31]
    ds_read_b64_tr_b16 v[64:65], v103 offset:16384
    ds_read_b64_tr_b16 v[66:67], v103 offset:17152
    v_mfma_f32_32x32x16_bf16 v[32:47], v[80:83], v[180:183], v[32:47]
    ds_read_b64_tr_b16 v[68:69], v103 offset:16448
    ds_read_b64_tr_b16 v[70:71], v103 offset:17216
    v_mfma_f32_32x32x16_bf16 v[48:63], v[84:87], v[180:183], v[48:63]
    ds_read_b64_tr_b16 v[72:73], v103 offset:16512
    ds_read_b64_tr_b16 v[74:75], v103 offset:17280
    s_waitcnt lgkmcnt(6)
    v_readfirstlane_b32 s67, v3
    s_cmp_ge_u32 s67, 4
    s_cbranch_scc1 L_syok_1004
    s_mov_b32 s66, 0
L_spin_1005:
    ds_read_b32 v3, v12 offset:8
    s_add_u32 s66, s66, 1
    s_cmp_gt_u32 s66, 400000
    s_cbranch_scc1 L_spinx_1006
    s_waitcnt lgkmcnt(0)
    v_readfirstlane_b32 s67, v3
    s_cmp_ge_u32 s67, 4
    s_cbranch_scc1 L_spinx_1006
    s_branch L_spin_1005
L_spinx_1006:
    s_waitcnt lgkmcnt(0)
L_syok_1004:
    v_mfma_f32_32x32x16_bf16 v[16:31], v[88:91], v[184:187], v[16:31]
    ds_read_b64_tr_b16 v[76:77], v104 offset:24576
    ds_read_b64_tr_b16 v[78:79], v104 offset:25344
    v_mfma_f32_32x32x16_bf16 v[32:47], v[92:95], v[184:187], v[32:47]
    ds_read_b64_tr_b16 v[80:81], v104 offset:24640
    ds_read_b64_tr_b16 v[82:83], v104 offset:25408
    v_mfma_f32_32x32x16_bf16 v[48:63], v[96:99], v[184:187], v[48:63]
    ds_read_b64_tr_b16 v[84:85], v104 offset:24704
    ds_read_b64_tr_b16 v[86:87], v104 offset:25472
    s_mov_b32 s66, 0
L_stat_1007:
    v_cmp_ne_u32 vcc, s61, v5
    v_cmp_ne_u32_e64 s[64:65], s61, v7
    s_nop 4
    s_or_b64 vcc, vcc, s[64:65]
    s_cbranch_scc0 L_statx_1008
    s_add_u32 s66, s66, 1
    s_cmp_gt_u32 s66, 400000
    s_cbranch_scc1 L_statx_1008
    buffer_load_dwordx4 v[4:7], v11, s[32:35], 0 offen sc1
    s_waitcnt vmcnt(0)
    s_branch L_stat_1007
L_statx_1008:
    s_waitcnt lgkmcnt(6)
    v_mfma_f32_32x32x16_bf16 v[16:31], v[64:67], v[188:191], v[16:31]
    ds_read_b64_tr_b16 v[88:89], v105 offset:24576
    ds_read_b64_tr_b16 v[90:91], v105 offset:25344
    v_mul_f32 v160, v6, v6
    v_mov_b32 v162, 0x3f800054
    v_mfma_f32_32x32x16_bf16 v[32:47], v[68:71], v[188:191], v[32:47]
    ds_read_b64_tr_b16 v[92:93], v105 offset:24640
    ds_read_b64_tr_b16 v[94:95], v105 offset:25408
    v_fmamk_f32 v160, v160, 0xb727c5ac, v162
    v_rsq_f32 v160, v160
    v_mfma_f32_32x32x16_bf16 v[48:63], v[72:75], v[188:191], v[48:63]
    ds_read_b64_tr_b16 v[96:97], v105 offset:24704
    ds_read_b64_tr_b16 v[98:99], v105 offset:25472
    v_mul_f32 v160, v160, v6
    v_rcp_f32 v162, v160
    s_mov_b64 exec, 1
    ds_add_u32 v12, v13 offset:64
    s_mov_b64 exec, -1
    s_waitcnt lgkmcnt(7)
    v_mfma_f32_32x32x16_bf16 v[16:31], v[76:79], v[192:195], v[16:31]
    ds_read_b64_tr_b16 v[64:65], v106 offset:24576
    ds_read_b64_tr_b16 v[66:67], v106 offset:25344
    v_mfma_f32_16x16x32_bf16 v[108:111], v[120:123], v[76:79], v[108:111]
    v_mul_f32 v164, 0xc0135761, v160
    v_mul_f32 v166, v160, v160
    v_mfma_f32_32x32x16_bf16 v[32:47], v[80:83], v[192:195], v[32:47]
    ds_read_b64_tr_b16 v[68:69], v106 offset:24640
    ds_read_b64_tr_b16 v[70:71], v106 offset:25408
    v_mfma_f32_16x16x32_bf16 v[112:115], v[120:123], v[80:83], v[112:115]
    v_mul_f32 v166, v166, v160
    v_mul_f32 v166, 0xbdd2d3e8, v166
    v_mfma_f32_32x32x16_bf16 v[48:63], v[84:87], v[192:195], v[48:63]
    ds_read_b64_tr_b16 v[72:73], v106 offset:24704
    ds_read_b64_tr_b16 v[74:75], v106 offset:25472
    v_mfma_f32_16x16x32_bf16 v[116:119], v[120:123], v[84:87], v[116:119]
    v_mov_b32 v168, 0xffff
    v_sub_f32 v173, 0, v4
    s_waitcnt lgkmcnt(7)
    v_mfma_f32_32x32x16_bf16 v[16:31], v[88:91], v[196:199], v[16:31]
    ds_read_b64_tr_b16 v[76:77], v107 offset:24576
    ds_read_b64_tr_b16 v[78:79], v107 offset:25344
    v_cvt_pk_bf16_f32 v156, v173, v173
    v_and_b32 v172, 0xffff0000, v156
    v_mfma_f32_32x32x16_bf16 v[32:47], v[92:95], v[196:199], v[32:47]
    ds_read_b64_tr_b16 v[80:81], v107 offset:24640
    ds_read_b64_tr_b16 v[82:83], v107 offset:25408
    v_sub_f32 v172, v173, v172
    v_cvt_pk_bf16_f32 v171, v172, v172
    v_mfma_f32_32x32x16_bf16 v[48:63], v[96:99], v[196:199], v[48:63]
    ds_read_b64_tr_b16 v[84:85], v107 offset:24704
    ds_read_b64_tr_b16 v[86:87], v107 offset:25472
    v_cvt_pk_bf16_f32 v170, v162, v162
    v_and_b32 v172, 0xffff0000, v170
    s_waitcnt vmcnt(2)
    s_mov_b64 exec, 1
    ds_add_u32 v12, v13 offset:12
    s_mov_b64 exec, -1
    s_waitcnt lgkmcnt(7)
    v_mfma_f32_32x32x16_bf16 v[16:31], v[64:67], v[200:203], v[16:31]
    ds_read_b64_tr_b16 v[88:89], v100 offset:32768
    ds_read_b64_tr_b16 v[90:91], v100 offset:33536
    v_sub_f32 v172, v162, v172
    v_cvt_pk_bf16_f32 v173, v172, v172
    v_mfma_f32_32x32x16_bf16 v[32:47], v[68:71], v[200:203], v[32:47]
    ds_read_b64_tr_b16 v[92:93], v100 offset:32832
    ds_read_b64_tr_b16 v[94:95], v100 offset:33600
    v_bfi_b32 v157, v168, v171, v170
    v_and_b32 v158, 0xffff, v173
    v_mfma_f32_32x32x16_bf16 v[48:63], v[72:75], v[200:203], v[48:63]
    ds_read_b64_tr_b16 v[96:97], v100 offset:32896
    ds_read_b64_tr_b16 v[98:99], v100 offset:33664
    v_mov_b32 v159, 0
    v_cmp_gt_u32 vcc, 32, v0
    s_waitcnt lgkmcnt(7)
    v_mfma_f32_32x32x16_bf16 v[16:31], v[76:79], v[204:207], v[16:31]
    ds_read_b64_tr_b16 v[64:65], v101 offset:32768
    ds_read_b64_tr_b16 v[66:67], v101 offset:33536
    v_cndmask_b32 v156, 0, v156, vcc
    v_cndmask_b32 v157, 0, v157, vcc
    v_mfma_f32_32x32x16_bf16 v[32:47], v[80:83], v[204:207], v[32:47]
    ds_read_b64_tr_b16 v[68:69], v101 offset:32832
    ds_read_b64_tr_b16 v[70:71], v101 offset:33600
    v_cndmask_b32 v158, 0, v158, vcc
    v_lshrrev_b32 v178, 16, v8
    v_mfma_f32_32x32x16_bf16 v[48:63], v[84:87], v[204:207], v[48:63]
    ds_read_b64_tr_b16 v[72:73], v101 offset:32896
    ds_read_b64_tr_b16 v[74:75], v101 offset:33664
    v_mov_b32 v179, 0
    v_lshrrev_b32 v182, 16, v9
    s_waitcnt lgkmcnt(6)
    v_mfma_f32_32x32x16_bf16 v[16:31], v[88:91], v[208:211], v[16:31]
    ds_read_b64_tr_b16 v[76:77], v102 offset:32768
    ds_read_b64_tr_b16 v[78:79], v102 offset:33536
    v_mfma_f32_16x16x32_bf16 v[108:111], v[120:123], v[88:91], v[108:111]
    v_mov_b32 v183, 0
    v_lshrrev_b32 v186, 16, v10
    v_mfma_f32_32x32x16_bf16 v[32:47], v[92:95], v[208:211], v[32:47]
    ds_read_b64_tr_b16 v[80:81], v102 offset:32832
    ds_read_b64_tr_b16 v[82:83], v102 offset:33600
    v_mfma_f32_16x16x32_bf16 v[112:115], v[120:123], v[92:95], v[112:115]
    v_mov_b32 v187, 0
    v_mfma_f32_32x32x16_bf16 v[48:63], v[96:99], v[208:211], v[48:63]
    ds_read_b64_tr_b16 v[84:85], v102 offset:32896
    ds_read_b64_tr_b16 v[86:87], v102 offset:33664
    v_mfma_f32_16x16x32_bf16 v[116:119], v[120:123], v[96:99], v[116:119]
    ds_read_b32 v3, v12 offset:12
    s_waitcnt lgkmcnt(7)
    v_mfma_f32_32x32x16_bf16 v[16:31], v[64:67], v[212:215], v[16:31]
    ds_read_b64_tr_b16 v[88:89], v103 offset:32768
    ds_read_b64_tr_b16 v[90:91], v103 offset:33536
    v_mfma_f32_32x32x16_bf16 v[32:47], v[68:71], v[212:215], v[32:47]
    ds_read_b64_tr_b16 v[92:93], v103 offset:32832
    ds_read_b64_tr_b16 v[94:95], v103 offset:33600
    v_mfma_f32_32x32x16_bf16 v[48:63], v[72:75], v[212:215], v[48:63]
    ds_read_b64_tr_b16 v[96:97], v103 offset:32896
    ds_read_b64_tr_b16 v[98:99], v103 offset:33664
    s_waitcnt lgkmcnt(6)
    v_readfirstlane_b32 s67, v3
    s_cmp_ge_u32 s67, 4
    s_cbranch_scc1 L_syok_1009
    s_mov_b32 s66, 0
L_spin_1010:
    ds_read_b32 v3, v12 offset:12
    s_add_u32 s66, s66, 1
    s_cmp_gt_u32 s66, 400000
    s_cbranch_scc1 L_spinx_1011
    s_waitcnt lgkmcnt(0)
    v_readfirstlane_b32 s67, v3
    s_cmp_ge_u32 s67, 4
    s_cbranch_scc1 L_spinx_1011
    s_branch L_spin_1010
L_spinx_1011:
    s_waitcnt lgkmcnt(0)
L_syok_1009:
    v_mfma_f32_32x32x16_bf16 v[16:31], v[76:79], v[216:219], v[16:31]
    ds_read_b64_tr_b16 v[64:65], v104 offset:36864
    ds_read_b64_tr_b16 v[66:67], v104 offset:37632
    v_mfma_f32_32x32x16_bf16 v[32:47], v[80:83], v[216:219], v[32:47]
    ds_read_b64_tr_b16 v[68:69], v104 offset:36928
    ds_read_b64_tr_b16 v[70:71], v104 offset:37696
    v_mfma_f32_32x32x16_bf16 v[48:63], v[84:87], v[216:219], v[48:63]
    ds_read_b64_tr_b16 v[72:73], v104 offset:36992
    ds_read_b64_tr_b16 v[74:75], v104 offset:37760
    s_waitcnt lgkmcnt(6)
    v_mfma_f32_32x32x16_bf16 v[16:31], v[88:91], v[220:223], v[16:31]
    ds_read_b64_tr_b16 v[76:77], v105 offset:36864
    ds_read_b64_tr_b16 v[78:79], v105 offset:37632
    v_mfma_f32_32x32x16_bf16 v[32:47], v[92:95], v[220:223], v[32:47]
    ds_read_b64_tr_b16 v[80:81], v105 offset:36928
    ds_read_b64_tr_b16 v[82:83], v105 offset:37696
    v_mfma_f32_32x32x16_bf16 v[48:63], v[96:99], v[220:223], v[48:63]
    ds_read_b64_tr_b16 v[84:85], v105 offset:36992
    ds_read_b64_tr_b16 v[86:87], v105 offset:37760
    s_waitcnt lgkmcnt(6)
    v_mfma_f32_32x32x16_bf16 v[16:31], v[64:67], v[224:227], v[16:31]
    ds_read_b64_tr_b16 v[88:89], v106 offset:36864
    ds_read_b64_tr_b16 v[90:91], v106 offset:37632
    v_mfma_f32_16x16x32_bf16 v[108:111], v[120:123], v[64:67], v[108:111]
    v_mfma_f32_32x32x16_bf16 v[32:47], v[68:71], v[224:227], v[32:47]
    ds_read_b64_tr_b16 v[92:93], v106 offset:36928
    ds_read_b64_tr_b16 v[94:95], v106 offset:37696
    v_mfma_f32_16x16x32_bf16 v[112:115], v[120:123], v[68:71], v[112:115]
    v_mfma_f32_32x32x16_bf16 v[48:63], v[72:75], v[224:227], v[48:63]
    ds_read_b64_tr_b16 v[96:97], v106 offset:36992
    ds_read_b64_tr_b16 v[98:99], v106 offset:37760
    v_mfma_f32_16x16x32_bf16 v[116:119], v[120:123], v[72:75], v[116:119]
    s_waitcnt lgkmcnt(6)
    v_mfma_f32_32x32x16_bf16 v[16:31], v[76:79], v[228:231], v[16:31]
    ds_read_b64_tr_b16 v[64:65], v107 offset:36864
    ds_read_b64_tr_b16 v[66:67], v107 offset:37632
    v_mfma_f32_32x32x16_bf16 v[32:47], v[80:83], v[228:231], v[32:47]
    ds_read_b64_tr_b16 v[68:69], v107 offset:36928
    ds_read_b64_tr_b16 v[70:71], v107 offset:37696
    v_mfma_f32_32x32x16_bf16 v[48:63], v[84:87], v[228:231], v[48:63]
    ds_read_b64_tr_b16 v[72:73], v107 offset:36992
    ds_read_b64_tr_b16 v[74:75], v107 offset:37760
    s_waitcnt lgkmcnt(6)
    v_mfma_f32_32x32x16_bf16 v[16:31], v[88:91], v[232:235], v[16:31]
    ds_read_b64_tr_b16 v[76:77], v100 offset:49152
    ds_read_b64_tr_b16 v[78:79], v100 offset:49920
    v_mfma_f32_32x32x16_bf16 v[32:47], v[92:95], v[232:235], v[32:47]
    ds_read_b64_tr_b16 v[80:81], v100 offset:49216
    ds_read_b64_tr_b16 v[82:83], v100 offset:49984
    v_mfma_f32_32x32x16_bf16 v[48:63], v[96:99], v[232:235], v[48:63]
    ds_read_b64_tr_b16 v[84:85], v100 offset:49280
    ds_read_b64_tr_b16 v[86:87], v100 offset:50048
    s_waitcnt lgkmcnt(6)
    v_mfma_f32_32x32x16_bf16 v[16:31], v[64:67], v[236:239], v[16:31]
    ds_read_b64_tr_b16 v[88:89], v101 offset:49152
    ds_read_b64_tr_b16 v[90:91], v101 offset:49920
    v_mfma_f32_32x32x16_bf16 v[32:47], v[68:71], v[236:239], v[32:47]
    ds_read_b64_tr_b16 v[92:93], v101 offset:49216
    ds_read_b64_tr_b16 v[94:95], v101 offset:49984
    v_mfma_f32_32x32x16_bf16 v[48:63], v[72:75], v[236:239], v[48:63]
    ds_read_b64_tr_b16 v[96:97], v101 offset:49280
    ds_read_b64_tr_b16 v[98:99], v101 offset:50048
    s_waitcnt lgkmcnt(6)
    v_mfma_f32_32x32x16_bf16 v[16:31], v[76:79], v[240:243], v[16:31]
    ds_read_b64_tr_b16 v[64:65], v102 offset:49152
    ds_read_b64_tr_b16 v[66:67], v102 offset:49920
    v_mfma_f32_16x16x32_bf16 v[108:111], v[120:123], v[76:79], v[108:111]
    v_mfma_f32_32x32x16_bf16 v[32:47], v[80:83], v[240:243], v[32:47]
    ds_read_b64_tr_b16 v[68:69], v102 offset:49216
    ds_read_b64_tr_b16 v[70:71], v102 offset:49984
    v_mfma_f32_16x16x32_bf16 v[112:115], v[120:123], v[80:83], v[112:115]
    v_mfma_f32_32x32x16_bf16 v[48:63], v[84:87], v[240:243], v[48:63]
    ds_read_b64_tr_b16 v[72:73], v102 offset:49280
    ds_read_b64_tr_b16 v[74:75], v102 offset:50048
    v_mfma_f32_16x16x32_bf16 v[116:119], v[120:123], v[84:87], v[116:119]
    s_waitcnt lgkmcnt(6)
    v_mfma_f32_32x32x16_bf16 v[16:31], v[88:91], v[244:247], v[16:31]
    ds_read_b64_tr_b16 v[76:77], v103 offset:49152
    ds_read_b64_tr_b16 v[78:79], v103 offset:49920
    v_mfma_f32_32x32x16_bf16 v[32:47], v[92:95], v[244:247], v[32:47]
    ds_read_b64_tr_b16 v[80:81], v103 offset:49216
    ds_read_b64_tr_b16 v[82:83], v103 offset:49984
    v_mfma_f32_32x32x16_bf16 v[48:63], v[96:99], v[244:247], v[48:63]
    ds_read_b64_tr_b16 v[84:85], v103 offset:49280
    ds_read_b64_tr_b16 v[86:87], v103 offset:50048
    s_mov_b64 exec, 0xffff
    ds_write2_b32 v14, v108, v109 offset0:0 offset1:16
    ds_write2_b32 v14, v112, v113 offset0:32 offset1:48
    ds_write2_b32 v14, v116, v117 offset0:64 offset1:80
    s_mov_b64 exec, -1
    s_mov_b64 exec, 1
    ds_add_u32 v12, v13 offset:0
    s_mov_b64 exec, -1
    s_waitcnt lgkmcnt(10)
    v_mfma_f32_32x32x16_bf16 v[16:31], v[64:67], v[248:251], v[16:31]
    v_mfma_f32_32x32x16_bf16 v[32:47], v[68:71], v[248:251], v[32:47]
    v_mfma_f32_32x32x16_bf16 v[48:63], v[72:75], v[248:251], v[48:63]
    s_waitcnt lgkmcnt(4)
    v_mfma_f32_32x32x16_bf16 v[16:31], v[76:79], v[252:255], v[16:31]
    v_mfma_f32_32x32x16_bf16 v[32:47], v[80:83], v[252:255], v[32:47]
    v_mfma_f32_32x32x16_bf16 v[48:63], v[84:87], v[252:255], v[48:63]
    ds_read_b32 v3, v12 offset:0
    s_mov_b64 exec, 1
    ds_add_u32 v12, v13 offset:16
    s_mov_b64 exec, -1
    s_setprio 3
    s_waitcnt lgkmcnt(1)
    v_readfirstlane_b32 s67, v3
    s_cmp_ge_u32 s67, 4
    s_cbranch_scc1 L_syok_1012
    s_mov_b32 s66, 0
L_spin_1013:
    ds_read_b32 v3, v12 offset:0
    s_add_u32 s66, s66, 1
    s_cmp_gt_u32 s66, 400000
    s_cbranch_scc1 L_spinx_1014
    s_waitcnt lgkmcnt(0)
    v_readfirstlane_b32 s67, v3
    s_cmp_ge_u32 s67, 4
    s_cbranch_scc1 L_spinx_1014
    s_branch L_spin_1013
L_spinx_1014:
    s_waitcnt lgkmcnt(0)
L_syok_1012:
    ds_read_b32 v108, v15 offset:0
    ds_read_b32 v109, v15 offset:768
    ds_read_b32 v110, v15 offset:1536
    ds_read_b32 v111, v15 offset:2304
    ds_read_b32 v112, v15 offset:128
    ds_read_b32 v113, v15 offset:896
    ds_read_b32 v114, v15 offset:1664
    ds_read_b32 v115, v15 offset:2432
    ds_read_b32 v116, v15 offset:256
    ds_read_b32 v117, v15 offset:1024
    ds_read_b32 v118, v15 offset:1792
    ds_read_b32 v119, v15 offset:2560
    s_waitcnt lgkmcnt(8)
    v_add_f32 v108, v108, v109
    v_add_f32 v110, v110, v111
    v_add_f32 v108, v108, v110
    v_cvt_pk_bf16_f32 v170, v108, v108
    v_and_b32 v172, 0xffff0000, v170
    v_sub_f32 v172, v108, v172
    v_cvt_pk_bf16_f32 v171, v172, v172
    v_bfi_b32 v176, v168, v170, v171
    v_bfi_b32 v177, v168, v170, v8
    s_nop 1
    v_mfma_f32_32x32x16_bf16 v[16:31], v[176:179], v[156:159], v[16:31]
    s_waitcnt lgkmcnt(4)
    v_add_f32 v112, v112, v113
    v_add_f32 v114, v114, v115
    v_add_f32 v112, v112, v114
    v_cvt_pk_bf16_f32 v170, v112, v112
    v_and_b32 v172, 0xffff0000, v170
    v_sub_f32 v172, v112, v172
    v_cvt_pk_bf16_f32 v171, v172, v172
    v_bfi_b32 v180, v168, v170, v171
    v_bfi_b32 v181, v168, v170, v9
    s_nop 1
    v_mfma_f32_32x32x16_bf16 v[32:47], v[180:183], v[156:159], v[32:47]
    s_waitcnt lgkmcnt(0)
    v_add_f32 v116, v116, v117
    v_add_f32 v118, v118, v119
    v_add_f32 v116, v116, v118
    v_cvt_pk_bf16_f32 v170, v116, v116
    v_and_b32 v172, 0xffff0000, v170
    v_sub_f32 v172, v116, v172
    v_cvt_pk_bf16_f32 v171, v172, v172
    v_bfi_b32 v184, v168, v170, v171
    v_bfi_b32 v185, v168, v170, v10
    s_nop 1
    v_mfma_f32_32x32x16_bf16 v[48:63], v[184:187], v[156:159], v[48:63]
    v_lshlrev_b32 v2, 4, v0
    v_pk_mul_f32 v[100:101], v[16:17], v[16:17]
    v_pk_mul_f32 v[102:103], v[18:19], v[18:19]
    v_pk_fma_f32 v[100:101], v[100:101], v[166:167], v[164:165] op_sel_hi:[1,0,0]
    v_pk_fma_f32 v[102:103], v[102:103], v[166:167], v[164:165] op_sel_hi:[1,0,0]
    v_pk_mul_f32 v[100:101], v[100:101], v[16:17]
    v_pk_mul_f32 v[102:103], v[102:103], v[18:19]
    v_exp_f32 v100, v100
    v_exp_f32 v101, v101
    v_exp_f32 v102, v102
    v_exp_f32 v103, v103
    v_pk_fma_f32 v[100:101], v[100:101], v[162:163], v[162:163] op_sel_hi:[1,0,0]
    v_pk_fma_f32 v[102:103], v[102:103], v[162:163], v[162:163] op_sel_hi:[1,0,0]
    v_rcp_f32 v100, v100
    v_rcp_f32 v101, v101
    v_rcp_f32 v102, v102
    v_rcp_f32 v103, v103
    v_pk_mul_f32 v[100:101], v[100:101], v[16:17]
    v_pk_mul_f32 v[102:103], v[102:103], v[18:19]
    v_cvt_pk_bf16_f32 v64, v100, v101
    v_cvt_pk_bf16_f32 v65, v102, v103
    v_pk_mul_f32 v[100:101], v[20:21], v[20:21]
    v_pk_mul_f32 v[102:103], v[22:23], v[22:23]
    v_pk_fma_f32 v[100:101], v[100:101], v[166:167], v[164:165] op_sel_hi:[1,0,0]
    v_pk_fma_f32 v[102:103], v[102:103], v[166:167], v[164:165] op_sel_hi:[1,0,0]
    v_pk_mul_f32 v[100:101], v[100:101], v[20:21]
    v_pk_mul_f32 v[102:103], v[102:103], v[22:23]
    v_exp_f32 v100, v100
    v_exp_f32 v101, v101
    v_exp_f32 v102, v102
    v_exp_f32 v103, v103
    v_pk_fma_f32 v[100:101], v[100:101], v[162:163], v[162:163] op_sel_hi:[1,0,0]
    v_pk_fma_f32 v[102:103], v[102:103], v[162:163], v[162:163] op_sel_hi:[1,0,0]
    v_rcp_f32 v100, v100
    v_rcp_f32 v101, v101
    v_rcp_f32 v102, v102
    v_rcp_f32 v103, v103
    v_pk_mul_f32 v[100:101], v[100:101], v[20:21]
    v_pk_mul_f32 v[102:103], v[102:103], v[22:23]
    v_cvt_pk_bf16_f32 v66, v100, v101
    v_cvt_pk_bf16_f32 v67, v102, v103
    v_pk_mul_f32 v[100:101], v[24:25], v[24:25]
    v_pk_mul_f32 v[102:103], v[26:27], v[26:27]
    v_pk_fma_f32 v[100:101], v[100:101], v[166:167], v[164:165] op_sel_hi:[1,0,0]
    v_pk_fma_f32 v[102:103], v[102:103], v[166:167], v[164:165] op_sel_hi:[1,0,0]
    v_pk_mul_f32 v[100:101], v[100:101], v[24:25]
    v_pk_mul_f32 v[102:103], v[102:103], v[26:27]
    v_exp_f32 v100, v100
    v_exp_f32 v101, v101
    v_exp_f32 v102, v102
    v_exp_f32 v103, v103
    v_pk_fma_f32 v[100:101], v[100:101], v[162:163], v[162:163] op_sel_hi:[1,0,0]
    v_pk_fma_f32 v[102:103], v[102:103], v[162:163], v[162:163] op_sel_hi:[1,0,0]
    v_rcp_f32 v100, v100
    v_rcp_f32 v101, v101
    v_rcp_f32 v102, v102
    v_rcp_f32 v103, v103
    v_pk_mul_f32 v[100:101], v[100:101], v[24:25]
    v_pk_mul_f32 v[102:103], v[102:103], v[26:27]
    v_cvt_pk_bf16_f32 v68, v100, v101
    v_cvt_pk_bf16_f32 v69, v102, v103
    v_pk_mul_f32 v[100:101], v[28:29], v[28:29]
    v_pk_mul_f32 v[102:103], v[30:31], v[30:31]
    v_pk_fma_f32 v[100:101], v[100:101], v[166:167], v[164:165] op_sel_hi:[1,0,0]
    v_pk_fma_f32 v[102:103], v[102:103], v[166:167], v[164:165] op_sel_hi:[1,0,0]
    v_pk_mul_f32 v[100:101], v[100:101], v[28:29]
    v_pk_mul_f32 v[102:103], v[102:103], v[30:31]
    v_exp_f32 v100, v100
    v_exp_f32 v101, v101
    v_exp_f32 v102, v102
    v_exp_f32 v103, v103
    v_pk_fma_f32 v[100:101], v[100:101], v[162:163], v[162:163] op_sel_hi:[1,0,0]
    v_pk_fma_f32 v[102:103], v[102:103], v[162:163], v[162:163] op_sel_hi:[1,0,0]
    v_rcp_f32 v100, v100
    v_rcp_f32 v101, v101
    v_rcp_f32 v102, v102
    v_rcp_f32 v103, v103
    v_pk_mul_f32 v[100:101], v[100:101], v[28:29]
    v_pk_mul_f32 v[102:103], v[102:103], v[30:31]
    v_cvt_pk_bf16_f32 v70, v100, v101
    v_cvt_pk_bf16_f32 v71, v102, v103
    s_add_u32 s64, s69, 0
    s_cmp_lt_u32 s64, 43
    s_mov_b32 s48, s32
    s_mov_b32 s49, s33
    s_cselect_b32 s50, s34, 0
    s_mov_b32 s51, 0x20000
    s_mul_i32 s62, s72, 86
    s_lshl_b32 s64, s64, 1
    s_add_u32 s62, s62, s64
    s_lshl_b32 s62, s62, 10
    s_add_u32 s62, s62, 9437184
    buffer_store_dwordx4 v[64:67], v2, s[48:51], s62 offen offset:0 sc1
    buffer_store_dwordx4 v[68:71], v2, s[48:51], s62 offen offset:1024 sc1
    v_pk_mul_f32 v[100:101], v[32:33], v[32:33]
    v_pk_mul_f32 v[102:103], v[34:35], v[34:35]
    v_pk_fma_f32 v[100:101], v[100:101], v[166:167], v[164:165] op_sel_hi:[1,0,0]
    v_pk_fma_f32 v[102:103], v[102:103], v[166:167], v[164:165] op_sel_hi:[1,0,0]
    v_pk_mul_f32 v[100:101], v[100:101], v[32:33]
    v_pk_mul_f32 v[102:103], v[102:103], v[34:35]
    v_exp_f32 v100, v100
    v_exp_f32 v101, v101
    v_exp_f32 v102, v102
    v_exp_f32 v103, v103
    v_pk_fma_f32 v[100:101], v[100:101], v[162:163], v[162:163] op_sel_hi:[1,0,0]
    v_pk_fma_f32 v[102:103], v[102:103], v[162:163], v[162:163] op_sel_hi:[1,0,0]
    v_rcp_f32 v100, v100
    v_rcp_f32 v101, v101
    v_rcp_f32 v102, v102
    v_rcp_f32 v103, v103
    v_pk_mul_f32 v[100:101], v[100:101], v[32:33]
    v_pk_mul_f32 v[102:103], v[102:103], v[34:35]
    v_cvt_pk_bf16_f32 v72, v100, v101
    v_cvt_pk_bf16_f32 v73, v102, v103
    v_pk_mul_f32 v[100:101], v[36:37], v[36:37]
    v_pk_mul_f32 v[102:103], v[38:39], v[38:39]
    v_pk_fma_f32 v[100:101], v[100:101], v[166:167], v[164:165] op_sel_hi:[1,0,0]
    v_pk_fma_f32 v[102:103], v[102:103], v[166:167], v[164:165] op_sel_hi:[1,0,0]
    v_pk_mul_f32 v[100:101], v[100:101], v[36:37]
    v_pk_mul_f32 v[102:103], v[102:103], v[38:39]
    v_exp_f32 v100, v100
    v_exp_f32 v101, v101
    v_exp_f32 v102, v102
    v_exp_f32 v103, v103
    v_pk_fma_f32 v[100:101], v[100:101], v[162:163], v[162:163] op_sel_hi:[1,0,0]
    v_pk_fma_f32 v[102:103], v[102:103], v[162:163], v[162:163] op_sel_hi:[1,0,0]
    v_rcp_f32 v100, v100
    v_rcp_f32 v101, v101
    v_rcp_f32 v102, v102
    v_rcp_f32 v103, v103
    v_pk_mul_f32 v[100:101], v[100:101], v[36:37]
    v_pk_mul_f32 v[102:103], v[102:103], v[38:39]
    v_cvt_pk_bf16_f32 v74, v100, v101
    v_cvt_pk_bf16_f32 v75, v102, v103
    v_pk_mul_f32 v[100:101], v[40:41], v[40:41]
    v_pk_mul_f32 v[102:103], v[42:43], v[42:43]
    v_pk_fma_f32 v[100:101], v[100:101], v[166:167], v[164:165] op_sel_hi:[1,0,0]
    v_pk_fma_f32 v[102:103], v[102:103], v[166:167], v[164:165] op_sel_hi:[1,0,0]
    v_pk_mul_f32 v[100:101], v[100:101], v[40:41]
    v_pk_mul_f32 v[102:103], v[102:103], v[42:43]
    v_exp_f32 v100, v100
    v_exp_f32 v101, v101
    v_exp_f32 v102, v102
    v_exp_f32 v103, v103
    v_pk_fma_f32 v[100:101], v[100:101], v[162:163], v[162:163] op_sel_hi:[1,0,0]
    v_pk_fma_f32 v[102:103], v[102:103], v[162:163], v[162:163] op_sel_hi:[1,0,0]
    v_rcp_f32 v100, v100
    v_rcp_f32 v101, v101
    v_rcp_f32 v102, v102
    v_rcp_f32 v103, v103
    v_pk_mul_f32 v[100:101], v[100:101], v[40:41]
    v_pk_mul_f32 v[102:103], v[102:103], v[42:43]
    v_cvt_pk_bf16_f32 v76, v100, v101
    v_cvt_pk_bf16_f32 v77, v102, v103
    v_pk_mul_f32 v[100:101], v[44:45], v[44:45]
    v_pk_mul_f32 v[102:103], v[46:47], v[46:47]
    v_pk_fma_f32 v[100:101], v[100:101], v[166:167], v[164:165] op_sel_hi:[1,0,0]
    v_pk_fma_f32 v[102:103], v[102:103], v[166:167], v[164:165] op_sel_hi:[1,0,0]
    v_pk_mul_f32 v[100:101], v[100:101], v[44:45]
    v_pk_mul_f32 v[102:103], v[102:103], v[46:47]
    v_exp_f32 v100, v100
    v_exp_f32 v101, v101
    v_exp_f32 v102, v102
    v_exp_f32 v103, v103
    v_pk_fma_f32 v[100:101], v[100:101], v[162:163], v[162:163] op_sel_hi:[1,0,0]
    v_pk_fma_f32 v[102:103], v[102:103], v[162:163], v[162:163] op_sel_hi:[1,0,0]
    v_rcp_f32 v100, v100
    v_rcp_f32 v101, v101
    v_rcp_f32 v102, v102
    v_rcp_f32 v103, v103
    v_pk_mul_f32 v[100:101], v[100:101], v[44:45]
    v_pk_mul_f32 v[102:103], v[102:103], v[46:47]
    v_cvt_pk_bf16_f32 v78, v100, v101
    v_cvt_pk_bf16_f32 v79, v102, v103
    s_add_u32 s64, s69, 1
    s_cmp_lt_u32 s64, 43
    s_mov_b32 s48, s32
    s_mov_b32 s49, s33
    s_cselect_b32 s50, s34, 0
    s_mov_b32 s51, 0x20000
    s_mul_i32 s62, s72, 86
    s_lshl_b32 s64, s64, 1
    s_add_u32 s62, s62, s64
    s_lshl_b32 s62, s62, 10
    s_add_u32 s62, s62, 9437184
    buffer_store_dwordx4 v[72:75], v2, s[48:51], s62 offen offset:0 sc1
    buffer_store_dwordx4 v[76:79], v2, s[48:51], s62 offen offset:1024 sc1
    v_pk_mul_f32 v[100:101], v[48:49], v[48:49]
    v_pk_mul_f32 v[102:103], v[50:51], v[50:51]
    v_pk_fma_f32 v[100:101], v[100:101], v[166:167], v[164:165] op_sel_hi:[1,0,0]
    v_pk_fma_f32 v[102:103], v[102:103], v[166:167], v[164:165] op_sel_hi:[1,0,0]
    v_pk_mul_f32 v[100:101], v[100:101], v[48:49]
    v_pk_mul_f32 v[102:103], v[102:103], v[50:51]
    v_exp_f32 v100, v100
    v_exp_f32 v101, v101
    v_exp_f32 v102, v102
    v_exp_f32 v103, v103
    v_pk_fma_f32 v[100:101], v[100:101], v[162:163], v[162:163] op_sel_hi:[1,0,0]
    v_pk_fma_f32 v[102:103], v[102:103], v[162:163], v[162:163] op_sel_hi:[1,0,0]
    v_rcp_f32 v100, v100
    v_rcp_f32 v101, v101
    v_rcp_f32 v102, v102
    v_rcp_f32 v103, v103
    v_pk_mul_f32 v[100:101], v[100:101], v[48:49]
    v_pk_mul_f32 v[102:103], v[102:103], v[50:51]
    v_cvt_pk_bf16_f32 v80, v100, v101
    v_cvt_pk_bf16_f32 v81, v102, v103
    v_pk_mul_f32 v[100:101], v[52:53], v[52:53]
    v_pk_mul_f32 v[102:103], v[54:55], v[54:55]
    v_pk_fma_f32 v[100:101], v[100:101], v[166:167], v[164:165] op_sel_hi:[1,0,0]
    v_pk_fma_f32 v[102:103], v[102:103], v[166:167], v[164:165] op_sel_hi:[1,0,0]
    v_pk_mul_f32 v[100:101], v[100:101], v[52:53]
    v_pk_mul_f32 v[102:103], v[102:103], v[54:55]
    v_exp_f32 v100, v100
    v_exp_f32 v101, v101
    v_exp_f32 v102, v102
    v_exp_f32 v103, v103
    v_pk_fma_f32 v[100:101], v[100:101], v[162:163], v[162:163] op_sel_hi:[1,0,0]
    v_pk_fma_f32 v[102:103], v[102:103], v[162:163], v[162:163] op_sel_hi:[1,0,0]
    v_rcp_f32 v100, v100
    v_rcp_f32 v101, v101
    v_rcp_f32 v102, v102
    v_rcp_f32 v103, v103
    v_pk_mul_f32 v[100:101], v[100:101], v[52:53]
    v_pk_mul_f32 v[102:103], v[102:103], v[54:55]
    v_cvt_pk_bf16_f32 v82, v100, v101
    v_cvt_pk_bf16_f32 v83, v102, v103
    v_pk_mul_f32 v[100:101], v[56:57], v[56:57]
    v_pk_mul_f32 v[102:103], v[58:59], v[58:59]
    v_pk_fma_f32 v[100:101], v[100:101], v[166:167], v[164:165] op_sel_hi:[1,0,0]
    v_pk_fma_f32 v[102:103], v[102:103], v[166:167], v[164:165] op_sel_hi:[1,0,0]
    v_pk_mul_f32 v[100:101], v[100:101], v[56:57]
    v_pk_mul_f32 v[102:103], v[102:103], v[58:59]
    v_exp_f32 v100, v100
    v_exp_f32 v101, v101
    v_exp_f32 v102, v102
    v_exp_f32 v103, v103
    v_pk_fma_f32 v[100:101], v[100:101], v[162:163], v[162:163] op_sel_hi:[1,0,0]
    v_pk_fma_f32 v[102:103], v[102:103], v[162:163], v[162:163] op_sel_hi:[1,0,0]
    v_rcp_f32 v100, v100
    v_rcp_f32 v101, v101
    v_rcp_f32 v102, v102
    v_rcp_f32 v103, v103
    v_pk_mul_f32 v[100:101], v[100:101], v[56:57]
    v_pk_mul_f32 v[102:103], v[102:103], v[58:59]
    v_cvt_pk_bf16_f32 v84, v100, v101
    v_cvt_pk_bf16_f32 v85, v102, v103
    v_pk_mul_f32 v[100:101], v[60:61], v[60:61]
    v_pk_mul_f32 v[102:103], v[62:63], v[62:63]
    v_pk_fma_f32 v[100:101], v[100:101], v[166:167], v[164:165] op_sel_hi:[1,0,0]
    v_pk_fma_f32 v[102:103], v[102:103], v[166:167], v[164:165] op_sel_hi:[1,0,0]
    v_pk_mul_f32 v[100:101], v[100:101], v[60:61]
    v_pk_mul_f32 v[102:103], v[102:103], v[62:63]
    v_exp_f32 v100, v100
    v_exp_f32 v101, v101
    v_exp_f32 v102, v102
    v_exp_f32 v103, v103
    v_pk_fma_f32 v[100:101], v[100:101], v[162:163], v[162:163] op_sel_hi:[1,0,0]
    v_pk_fma_f32 v[102:103], v[102:103], v[162:163], v[162:163] op_sel_hi:[1,0,0]
    v_rcp_f32 v100, v100
    v_rcp_f32 v101, v101
    v_rcp_f32 v102, v102
    v_rcp_f32 v103, v103
    v_pk_mul_f32 v[100:101], v[100:101], v[60:61]
    v_pk_mul_f32 v[102:103], v[102:103], v[62:63]
    v_cvt_pk_bf16_f32 v86, v100, v101
    v_cvt_pk_bf16_f32 v87, v102, v103
    s_add_u32 s64, s69, 2
    s_cmp_lt_u32 s64, 43
    s_mov_b32 s48, s32
    s_mov_b32 s49, s33
    s_cselect_b32 s50, s34, 0
    s_mov_b32 s51, 0x20000
    s_mul_i32 s62, s72, 86
    s_lshl_b32 s64, s64, 1
    s_add_u32 s62, s62, s64
    s_lshl_b32 s62, s62, 10
    s_add_u32 s62, s62, 9437184
    buffer_store_dwordx4 v[80:83], v2, s[48:51], s62 offen offset:0 sc1
    buffer_store_dwordx4 v[84:87], v2, s[48:51], s62 offen offset:1024 sc1
    s_mov_b32 s40, s4
    s_mov_b32 s41, s5
    s_mov_b32 s42, 2097152
    s_mov_b32 s43, 0x20000
    s_mov_b32 s48, s18
    s_mov_b32 s49, s19
    s_mov_b32 s50, 1024
    s_mov_b32 s51, 0x20000
    s_lshr_b32 s65, s57, 1
    s_add_u32 s71, s78, s65
    s_and_b32 s70, s57, 1
    s_lshl_b32 s70, s70, 6
    s_lshl_b32 s64, s77, 7
    s_add_u32 s64, s64, s70
    v_lshrrev_b32 v154, 5, v0
    v_lshlrev_b32 v152, 3, v154
    v_add_u32 v152, s64, v152
    v_and_b32 v155, 31, v0
    s_lshl_b32 s64, s71, 5
    v_add_u32 v155, s64, v155
    v_lshl_add_u32 v153, v155, 10, v152
    buffer_load_dwordx2 v[136:137], v153, s[40:43], 0 offen offset:0
    buffer_load_dwordx2 v[144:145], v152, s[48:51], 0 offen offset:0
    buffer_load_dwordx2 v[138:139], v153, s[40:43], 0 offen offset:16
    buffer_load_dwordx2 v[146:147], v152, s[48:51], 0 offen offset:16
    buffer_load_dwordx2 v[140:141], v153, s[40:43], 0 offen offset:32
    buffer_load_dwordx2 v[148:149], v152, s[48:51], 0 offen offset:32
    buffer_load_dwordx2 v[142:143], v153, s[40:43], 0 offen offset:48
    buffer_load_dwordx2 v[150:151], v152, s[48:51], 0 offen offset:48
    s_mul_i32 s73, s57, 22528
    s_mul_i32 s64, s71, 88064
    s_add_u32 s64, s64, 9437184
    s_add_u32 s48, s24, s64
    s_addc_u32 s49, s25, 0
    s_mov_b32 s50, 88064
    s_mov_b32 s51, 0x20000
    s_xor_b32 s65, s71, 1
    s_mul_i32 s64, s65, 88064
    s_add_u32 s64, s64, 9437184
    s_add_u32 s40, s24, s64
    s_addc_u32 s41, s25, 0
    s_mov_b32 s42, 88064
    s_mov_b32 s43, 0x20000
    v_lshrrev_b32 v5, 5, v0
    v_lshlrev_b32 v10, 9, v5
    v_bfe_u32 v5, v0, 2, 2
    v_lshl_add_u32 v10, v5, 7, v10
    v_bfe_u32 v5, v0, 3, 1
    v_lshl_add_u32 v10, v5, 6, v10
    v_bfe_u32 v5, v0, 4, 1
    v_lshl_add_u32 v10, v5, 5, v10
    v_and_b32 v5, 3, v0
    v_lshl_add_u32 v10, v5, 3, v10
    v_add_u32 v10, s27, v10
    v_xor_b32 v11, 64, v10
    v_xor_b32 v10, s70, v10
    v_xor_b32 v11, s70, v11
    s_mul_i32 s64, s57, 473
    s_lshr_b32 s64, s64, 7
    s_min_u32 s64, s64, 10
    s_lshl_b32 s64, s64, 8
    s_lshr_b32 s68, s76, 1
    s_lshl_b32 s68, s68, 12
    s_add_u32 s68, s68, s64
    s_and_b32 s64, s76, 1
    s_lshl_b32 s64, s64, 3
    s_add_u32 s68, s68, s64
    s_lshl_b32 s62, s58, 4
    s_add_u32 s62, s62, s59
    s_lshl_b32 s62, s62, 8
    s_lshl_b32 s64, s57, 2
    s_add_u32 s62, s62, s64
    s_add_u32 s62, s62, 524416
    s_waitcnt vmcnt(8)
    v_mov_b32 v6, s61
    v_mov_b32 v7, 0
    s_mov_b64 exec, 1
    buffer_store_dword v6, v7, s[32:35], s62 offen sc1
    s_mov_b64 exec, -1
    s_mov_b32 s66, 0
L_spin_1015:
    ds_read_b32 v7, v12 offset:16
    s_add_u32 s66, s66, 1
    s_cmp_gt_u32 s66, 400000
    s_cbranch_scc1 L_spinx_1016
    s_waitcnt lgkmcnt(0)
    v_readfirstlane_b32 s67, v7
    s_cmp_ge_u32 s67, 4
    s_cbranch_scc1 L_spinx_1016
    s_branch L_spin_1015
L_spinx_1016:
    s_waitcnt lgkmcnt(0)
    s_add_u32 m0, s27, 32768
    s_add_u32 s74, s26, 65536
    buffer_load_dwordx4 v128, s[28:31], s74 offen offset:0  lds
    buffer_load_dwordx4 v129, s[28:31], s74 offen offset:1024  lds
    s_add_u32 m0, s27, 40960
    s_add_u32 s74, s26, 81920
    buffer_load_dwordx4 v128, s[28:31], s74 offen offset:0  lds
    buffer_load_dwordx4 v129, s[28:31], s74 offen offset:1024  lds
    s_add_u32 m0, s27, 49152
    s_add_u32 s74, s26, 98304
    buffer_load_dwordx4 v128, s[28:31], s74 offen offset:0  lds
    buffer_load_dwordx4 v129, s[28:31], s74 offen offset:1024  lds
    s_add_u32 m0, s27, 90112
    s_lshl_b32 s74, s57, 14
    s_add_u32 s74, s74, 196608
    buffer_load_dwordx4 v128, s[36:39], s74 offen offset:0  lds
    buffer_load_dwordx4 v129, s[36:39], s74 offen offset:1024  lds
    s_waitcnt vmcnt(9)
    v_lshlrev_b32 v14, 16, v136
    v_lshlrev_b32 v15, 16, v144
    v_add_f32 v16, v14, v15
    v_and_b32 v14, 0xffff0000, v136
    v_and_b32 v15, 0xffff0000, v144
    v_add_f32 v17, v14, v15
    v_lshlrev_b32 v14, 16, v137
    v_lshlrev_b32 v15, 16, v145
    v_add_f32 v18, v14, v15
    v_and_b32 v14, 0xffff0000, v137
    v_and_b32 v15, 0xffff0000, v145
    v_add_f32 v19, v14, v15
    v_lshlrev_b32 v14, 16, v138
    v_lshlrev_b32 v15, 16, v146
    v_add_f32 v20, v14, v15
    v_and_b32 v14, 0xffff0000, v138
    v_and_b32 v15, 0xffff0000, v146
    v_add_f32 v21, v14, v15
    v_lshlrev_b32 v14, 16, v139
    v_lshlrev_b32 v15, 16, v147
    v_add_f32 v22, v14, v15
    v_and_b32 v14, 0xffff0000, v139
    v_and_b32 v15, 0xffff0000, v147
    v_add_f32 v23, v14, v15
    v_lshlrev_b32 v14, 16, v140
    v_lshlrev_b32 v15, 16, v148
    v_add_f32 v24, v14, v15
    v_and_b32 v14, 0xffff0000, v140
    v_and_b32 v15, 0xffff0000, v148
    v_add_f32 v25, v14, v15
    v_lshlrev_b32 v14, 16, v141
    v_lshlrev_b32 v15, 16, v149
    v_add_f32 v26, v14, v15
    v_and_b32 v14, 0xffff0000, v141
    v_and_b32 v15, 0xffff0000, v149
    v_add_f32 v27, v14, v15
    v_lshlrev_b32 v14, 16, v142
    v_lshlrev_b32 v15, 16, v150
    v_add_f32 v28, v14, v15
    v_and_b32 v14, 0xffff0000, v142
    v_and_b32 v15, 0xffff0000, v150
    v_add_f32 v29, v14, v15
    v_lshlrev_b32 v14, 16, v143
    v_lshlrev_b32 v15, 16, v151
    v_add_f32 v30, v14, v15
    v_and_b32 v14, 0xffff0000, v143
    v_and_b32 v15, 0xffff0000, v151
    v_add_f32 v31, v14, v15
    s_mov_b32 s66, 0
    s_mov_b32 s64, s61
    s_mov_b32 s65, s61
L_spoll_1017:
    s_load_dwordx2 s[4:5], s[24:25], s68 offset:524416 glc
    s_load_dwordx2 s[6:7], s[24:25], s68 offset:524672 glc
    s_load_dwordx2 s[8:9], s[24:25], s68 offset:524928 glc
    s_load_dwordx2 s[10:11], s[24:25], s68 offset:525184 glc
    s_load_dwordx2 s[12:13], s[24:25], s68 offset:525440 glc
    s_add_u32 s66, s66, 1
    s_cmp_gt_u32 s66, 400000
    s_cbranch_scc1 L_spollx_1018
    s_waitcnt lgkmcnt(0)
    s_cmp_eq_u64 s[4:5], s[64:65]
    s_cbranch_scc0 L_spollr_1019
    s_cmp_eq_u64 s[6:7], s[64:65]
    s_cbranch_scc0 L_spollr_1019
    s_cmp_eq_u64 s[8:9], s[64:65]
    s_cbranch_scc0 L_spollr_1019
    s_cmp_eq_u64 s[10:11], s[64:65]
    s_cbranch_scc0 L_spollr_1019
    s_cmp_eq_u64 s[12:13], s[64:65]
    s_cbranch_scc1 L_spollx_1018
L_spollr_1019:
    s_sleep 8
    s_branch L_spoll_1017
L_spollx_1018:
    s_waitcnt lgkmcnt(0)
    s_setprio 0
    s_add_u32 s69, s73, 0
    buffer_load_dwordx4 v[176:179], v2, s[48:51], s69 offen sc1
    buffer_load_dwordx4 v[180:183], v2, s[40:43], s69 offen sc1
    s_add_u32 s69, s73, 1024
    buffer_load_dwordx4 v[184:187], v2, s[48:51], s69 offen sc1
    buffer_load_dwordx4 v[188:191], v2, s[40:43], s69 offen sc1
    s_add_u32 s69, s73, 2048
    buffer_load_dwordx4 v[192:195], v2, s[48:51], s69 offen sc1
    buffer_load_dwordx4 v[196:199], v2, s[40:43], s69 offen sc1
    s_add_u32 s69, s73, 3072
    buffer_load_dwordx4 v[200:203], v2, s[48:51], s69 offen sc1
    buffer_load_dwordx4 v[204:207], v2, s[40:43], s69 offen sc1
    s_add_u32 s69, s73, 4096
    buffer_load_dwordx4 v[208:211], v2, s[48:51], s69 offen sc1
    buffer_load_dwordx4 v[212:215], v2, s[40:43], s69 offen sc1
    s_mov_b32 s66, 0
L_spin_1020:
    ds_read_b32 v7, v12 offset:68
    s_add_u32 s66, s66, 1
    s_cmp_gt_u32 s66, 400000
    s_cbranch_scc1 L_spinx_1021
    s_waitcnt lgkmcnt(0)
    v_readfirstlane_b32 s67, v7
    s_cmp_ge_u32 s67, 4
    s_cbranch_scc1 L_spinx_1021
    s_branch L_spin_1020
L_spinx_1021:
    s_waitcnt lgkmcnt(0)
    ds_read_b64_tr_b16 v[160:161], v10 offset:0
    ds_read_b64_tr_b16 v[162:163], v10 offset:1024
    ds_read_b64_tr_b16 v[164:165], v11 offset:0
    ds_read_b64_tr_b16 v[166:167], v11 offset:1024
    ds_read_b64_tr_b16 v[168:169], v10 offset:8192
    ds_read_b64_tr_b16 v[170:171], v10 offset:9216
    ds_read_b64_tr_b16 v[172:173], v11 offset:8192
    ds_read_b64_tr_b16 v[174:175], v11 offset:9216
    s_waitcnt vmcnt(8) lgkmcnt(4)
    v_mfma_f32_32x32x16_bf16 v[16:31], v[160:163], v[176:179], v[16:31]
    s_add_u32 s69, s73, 5120
    buffer_load_dwordx4 v[216:219], v2, s[48:51], s69 offen sc1
    v_mfma_f32_32x32x16_bf16 v[32:47], v[164:167], v[176:179], 0
    buffer_load_dwordx4 v[220:223], v2, s[40:43], s69 offen sc1
    v_mfma_f32_32x32x16_bf16 v[48:63], v[160:163], v[180:183], 0
    s_add_u32 m0, s27, 57344
    s_add_u32 s74, s26, 114688
    buffer_load_dwordx4 v128, s[28:31], s74 offen offset:0  lds
    v_mfma_f32_32x32x16_bf16 v[64:79], v[164:167], v[180:183], 0
    buffer_load_dwordx4 v129, s[28:31], s74 offen offset:1024  lds
    s_mov_b64 exec, 1
    ds_add_u32 v12, v13 offset:20
    s_mov_b64 exec, -1
    ds_read_b64_tr_b16 v[160:161], v10 offset:16384
    ds_read_b64_tr_b16 v[162:163], v10 offset:17408
    ds_read_b64_tr_b16 v[164:165], v11 offset:16384
    ds_read_b64_tr_b16 v[166:167], v11 offset:17408
    s_waitcnt vmcnt(10) lgkmcnt(5)
    v_mfma_f32_32x32x16_bf16 v[16:31], v[168:171], v[184:187], v[16:31]
    s_add_u32 s69, s73, 6144
    buffer_load_dwordx4 v[224:227], v2, s[48:51], s69 offen sc1
    v_mfma_f32_32x32x16_bf16 v[32:47], v[172:175], v[184:187], v[32:47]
    buffer_load_dwordx4 v[228:231], v2, s[40:43], s69 offen sc1
    v_mfma_f32_32x32x16_bf16 v[48:63], v[168:171], v[188:191], v[48:63]
    s_add_u32 m0, s27, 0
    s_add_u32 s74, s26, 131072
    buffer_load_dwordx4 v128, s[28:31], s74 offen offset:0  lds
    v_mfma_f32_32x32x16_bf16 v[64:79], v[172:175], v[188:191], v[64:79]
    buffer_load_dwordx4 v129, s[28:31], s74 offen offset:1024  lds
    ds_read_b64_tr_b16 v[168:169], v10 offset:24576
    ds_read_b64_tr_b16 v[170:171], v10 offset:25600
    ds_read_b64_tr_b16 v[172:173], v11 offset:24576
    ds_read_b64_tr_b16 v[174:175], v11 offset:25600
    s_waitcnt vmcnt(12) lgkmcnt(4)
    v_mfma_f32_32x32x16_bf16 v[16:31], v[160:163], v[192:195], v[16:31]
    s_add_u32 s69, s73, 7168
    buffer_load_dwordx4 v[232:235], v2, s[48:51], s69 offen sc1
    v_mfma_f32_32x32x16_bf16 v[32:47], v[164:167], v[192:195], v[32:47]
    buffer_load_dwordx4 v[236:239], v2, s[40:43], s69 offen sc1
    v_mfma_f32_32x32x16_bf16 v[48:63], v[160:163], v[196:199], v[48:63]
    s_add_u32 m0, s27, 8192
    s_add_u32 s74, s26, 147456
    buffer_load_dwordx4 v128, s[28:31], s74 offen offset:0  lds
    v_mfma_f32_32x32x16_bf16 v[64:79], v[164:167], v[196:199], v[64:79]
    buffer_load_dwordx4 v129, s[28:31], s74 offen offset:1024  lds
    ds_read_b64_tr_b16 v[160:161], v10 offset:32768
    ds_read_b64_tr_b16 v[162:163], v10 offset:33792
    ds_read_b64_tr_b16 v[164:165], v11 offset:32768
    ds_read_b64_tr_b16 v[166:167], v11 offset:33792
    s_waitcnt vmcnt(14) lgkmcnt(4)
    v_mfma_f32_32x32x16_bf16 v[16:31], v[168:171], v[200:203], v[16:31]
    s_add_u32 s69, s73, 8192
    buffer_load_dwordx4 v[176:179], v2, s[48:51], s69 offen sc1
    v_mfma_f32_32x32x16_bf16 v[32:47], v[172:175], v[200:203], v[32:47]
    buffer_load_dwordx4 v[180:183], v2, s[40:43], s69 offen sc1
    v_mfma_f32_32x32x16_bf16 v[48:63], v[168:171], v[204:207], v[48:63]
    s_add_u32 m0, s27, 16384
    s_add_u32 s74, s26, 163840
    buffer_load_dwordx4 v128, s[28:31], s74 offen offset:0  lds
    v_mfma_f32_32x32x16_bf16 v[64:79], v[172:175], v[204:207], v[64:79]
    buffer_load_dwordx4 v129, s[28:31], s74 offen offset:1024  lds
    ds_read_b64_tr_b16 v[168:169], v10 offset:40960
    ds_read_b64_tr_b16 v[170:171], v10 offset:41984
    ds_read_b64_tr_b16 v[172:173], v11 offset:40960
    ds_read_b64_tr_b16 v[174:175], v11 offset:41984
    s_waitcnt vmcnt(16) lgkmcnt(4)
    v_mfma_f32_32x32x16_bf16 v[16:31], v[160:163], v[208:211], v[16:31]
    s_add_u32 s69, s73, 9216
    buffer_load_dwordx4 v[184:187], v2, s[48:51], s69 offen sc1
    v_mfma_f32_32x32x16_bf16 v[32:47], v[164:167], v[208:211], v[32:47]
    buffer_load_dwordx4 v[188:191], v2, s[40:43], s69 offen sc1
    v_mfma_f32_32x32x16_bf16 v[48:63], v[160:163], v[212:215], v[48:63]
    s_add_u32 m0, s27, 24576
    s_add_u32 s74, s26, 180224
    buffer_load_dwordx4 v128, s[28:31], s74 offen offset:0  lds
    v_mfma_f32_32x32x16_bf16 v[64:79], v[164:167], v[212:215], v[64:79]
    buffer_load_dwordx4 v129, s[28:31], s74 offen offset:1024  lds
    ds_read_b64_tr_b16 v[160:161], v10 offset:49152
    ds_read_b64_tr_b16 v[162:163], v10 offset:50176
    ds_read_b64_tr_b16 v[164:165], v11 offset:49152
    ds_read_b64_tr_b16 v[166:167], v11 offset:50176
    s_waitcnt vmcnt(18) lgkmcnt(4)
    v_mfma_f32_32x32x16_bf16 v[16:31], v[168:171], v[216:219], v[16:31]
    s_add_u32 s69, s73, 10240
    buffer_load_dwordx4 v[192:195], v2, s[48:51], s69 offen sc1
    v_mfma_f32_32x32x16_bf16 v[32:47], v[172:175], v[216:219], v[32:47]
    buffer_load_dwordx4 v[196:199], v2, s[40:43], s69 offen sc1
    v_mfma_f32_32x32x16_bf16 v[48:63], v[168:171], v[220:223], v[48:63]
    s_add_u32 m0, s27, 32768
    s_add_u32 s74, s26, 196608
    buffer_load_dwordx4 v128, s[28:31], s74 offen offset:0  lds
    v_mfma_f32_32x32x16_bf16 v[64:79], v[172:175], v[220:223], v[64:79]
    buffer_load_dwordx4 v129, s[28:31], s74 offen offset:1024  lds
    s_waitcnt vmcnt(20)
    ds_read_b64_tr_b16 v[168:169], v10 offset:57344
    ds_read_b64_tr_b16 v[170:171], v10 offset:58368
    ds_read_b64_tr_b16 v[172:173], v11 offset:57344
    ds_read_b64_tr_b16 v[174:175], v11 offset:58368
    s_waitcnt vmcnt(18) lgkmcnt(4)
    v_mfma_f32_32x32x16_bf16 v[16:31], v[160:163], v[224:227], v[16:31]
    s_add_u32 s69, s73, 11264
    buffer_load_dwordx4 v[200:203], v2, s[48:51], s69 offen sc1
    v_mfma_f32_32x32x16_bf16 v[32:47], v[164:167], v[224:227], v[32:47]
    buffer_load_dwordx4 v[204:207], v2, s[40:43], s69 offen sc1
    v_mfma_f32_32x32x16_bf16 v[48:63], v[160:163], v[228:231], v[48:63]
    s_add_u32 m0, s27, 40960
    s_add_u32 s74, s26, 212992
    buffer_load_dwordx4 v128, s[28:31], s74 offen offset:0  lds
    v_mfma_f32_32x32x16_bf16 v[64:79], v[164:167], v[228:231], v[64:79]
    buffer_load_dwordx4 v129, s[28:31], s74 offen offset:1024  lds
    s_waitcnt vmcnt(20)
    ds_read_b64_tr_b16 v[160:161], v10 offset:0
    ds_read_b64_tr_b16 v[162:163], v10 offset:1024
    ds_read_b64_tr_b16 v[164:165], v11 offset:0
    ds_read_b64_tr_b16 v[166:167], v11 offset:1024
    s_waitcnt vmcnt(18) lgkmcnt(4)
    v_mfma_f32_32x32x16_bf16 v[16:31], v[168:171], v[232:235], v[16:31]
    s_add_u32 s69, s73, 12288
    buffer_load_dwordx4 v[208:211], v2, s[48:51], s69 offen sc1
    v_mfma_f32_32x32x16_bf16 v[32:47], v[172:175], v[232:235], v[32:47]
    buffer_load_dwordx4 v[212:215], v2, s[40:43], s69 offen sc1
    v_mfma_f32_32x32x16_bf16 v[48:63], v[168:171], v[236:239], v[48:63]
    s_add_u32 m0, s27, 49152
    s_add_u32 s74, s26, 229376
    buffer_load_dwordx4 v128, s[28:31], s74 offen offset:0  lds
    v_mfma_f32_32x32x16_bf16 v[64:79], v[172:175], v[236:239], v[64:79]
    buffer_load_dwordx4 v129, s[28:31], s74 offen offset:1024  lds
    s_waitcnt vmcnt(20)
    ds_read_b64_tr_b16 v[168:169], v10 offset:8192
    ds_read_b64_tr_b16 v[170:171], v10 offset:9216
    ds_read_b64_tr_b16 v[172:173], v11 offset:8192
    ds_read_b64_tr_b16 v[174:175], v11 offset:9216
    s_waitcnt vmcnt(18) lgkmcnt(4)
    v_mfma_f32_32x32x16_bf16 v[16:31], v[160:163], v[176:179], v[16:31]
    s_add_u32 s69, s73, 13312
    buffer_load_dwordx4 v[216:219], v2, s[48:51], s69 offen sc1
    v_mfma_f32_32x32x16_bf16 v[32:47], v[164:167], v[176:179], v[32:47]
    buffer_load_dwordx4 v[220:223], v2, s[40:43], s69 offen sc1
    v_mfma_f32_32x32x16_bf16 v[48:63], v[160:163], v[180:183], v[48:63]
    s_add_u32 m0, s27, 57344
    s_add_u32 s74, s26, 245760
    buffer_load_dwordx4 v128, s[28:31], s74 offen offset:0  lds
    v_mfma_f32_32x32x16_bf16 v[64:79], v[164:167], v[180:183], v[64:79]
    buffer_load_dwordx4 v129, s[28:31], s74 offen offset:1024  lds
    s_waitcnt vmcnt(20)
    ds_read_b64_tr_b16 v[160:161], v10 offset:16384
    ds_read_b64_tr_b16 v[162:163], v10 offset:17408
    ds_read_b64_tr_b16 v[164:165], v11 offset:16384
    ds_read_b64_tr_b16 v[166:167], v11 offset:17408
    s_waitcnt vmcnt(18) lgkmcnt(4)
    v_mfma_f32_32x32x16_bf16 v[16:31], v[168:171], v[184:187], v[16:31]
    s_add_u32 s69, s73, 14336
    buffer_load_dwordx4 v[224:227], v2, s[48:51], s69 offen sc1
    v_mfma_f32_32x32x16_bf16 v[32:47], v[172:175], v[184:187], v[32:47]
    buffer_load_dwordx4 v[228:231], v2, s[40:43], s69 offen sc1
    v_mfma_f32_32x32x16_bf16 v[48:63], v[168:171], v[188:191], v[48:63]
    s_add_u32 m0, s27, 0
    s_add_u32 s74, s26, 262144
    buffer_load_dwordx4 v128, s[28:31], s74 offen offset:0  lds
    v_mfma_f32_32x32x16_bf16 v[64:79], v[172:175], v[188:191], v[64:79]
    buffer_load_dwordx4 v129, s[28:31], s74 offen offset:1024  lds
    s_waitcnt vmcnt(20)
    ds_read_b64_tr_b16 v[168:169], v10 offset:24576
    ds_read_b64_tr_b16 v[170:171], v10 offset:25600
    ds_read_b64_tr_b16 v[172:173], v11 offset:24576
    ds_read_b64_tr_b16 v[174:175], v11 offset:25600
    s_waitcnt vmcnt(18) lgkmcnt(4)
    v_mfma_f32_32x32x16_bf16 v[16:31], v[160:163], v[192:195], v[16:31]
    s_add_u32 s69, s73, 15360
    buffer_load_dwordx4 v[232:235], v2, s[48:51], s69 offen sc1
    v_mfma_f32_32x32x16_bf16 v[32:47], v[164:167], v[192:195], v[32:47]
    buffer_load_dwordx4 v[236:239], v2, s[40:43], s69 offen sc1
    v_mfma_f32_32x32x16_bf16 v[48:63], v[160:163], v[196:199], v[48:63]
    s_add_u32 m0, s27, 8192
    s_add_u32 s74, s26, 278528
    buffer_load_dwordx4 v128, s[28:31], s74 offen offset:0  lds
    v_mfma_f32_32x32x16_bf16 v[64:79], v[164:167], v[196:199], v[64:79]
    buffer_load_dwordx4 v129, s[28:31], s74 offen offset:1024  lds
    s_waitcnt vmcnt(20)
    ds_read_b64_tr_b16 v[160:161], v10 offset:32768
    ds_read_b64_tr_b16 v[162:163], v10 offset:33792
    ds_read_b64_tr_b16 v[164:165], v11 offset:32768
    ds_read_b64_tr_b16 v[166:167], v11 offset:33792
    s_waitcnt vmcnt(18) lgkmcnt(4)
    v_mfma_f32_32x32x16_bf16 v[16:31], v[168:171], v[200:203], v[16:31]
    s_add_u32 s69, s73, 16384
    buffer_load_dwordx4 v[176:179], v2, s[48:51], s69 offen sc1
    v_mfma_f32_32x32x16_bf16 v[32:47], v[172:175], v[200:203], v[32:47]
    buffer_load_dwordx4 v[180:183], v2, s[40:43], s69 offen sc1
    v_mfma_f32_32x32x16_bf16 v[48:63], v[168:171], v[204:207], v[48:63]
    s_add_u32 m0, s27, 16384
    s_add_u32 s74, s26, 294912
    buffer_load_dwordx4 v128, s[28:31], s74 offen offset:0  lds
    v_mfma_f32_32x32x16_bf16 v[64:79], v[172:175], v[204:207], v[64:79]
    buffer_load_dwordx4 v129, s[28:31], s74 offen offset:1024  lds
    s_mov_b64 exec, 1
    ds_add_u32 v12, v13 offset:24
    s_mov_b64 exec, -1
    s_waitcnt vmcnt(20)
    ds_read_b64_tr_b16 v[168:169], v10 offset:40960
    ds_read_b64_tr_b16 v[170:171], v10 offset:41984
    ds_read_b64_tr_b16 v[172:173], v11 offset:40960
    ds_read_b64_tr_b16 v[174:175], v11 offset:41984
    s_waitcnt vmcnt(18) lgkmcnt(5)
    v_mfma_f32_32x32x16_bf16 v[16:31], v[160:163], v[208:211], v[16:31]
    s_add_u32 s69, s73, 17408
    buffer_load_dwordx4 v[184:187], v2, s[48:51], s69 offen sc1
    v_mfma_f32_32x32x16_bf16 v[32:47], v[164:167], v[208:211], v[32:47]
    buffer_load_dwordx4 v[188:191], v2, s[40:43], s69 offen sc1
    v_mfma_f32_32x32x16_bf16 v[48:63], v[160:163], v[212:215], v[48:63]
    s_add_u32 m0, s27, 24576
    s_add_u32 s74, s26, 311296
    buffer_load_dwordx4 v128, s[28:31], s74 offen offset:0  lds
    v_mfma_f32_32x32x16_bf16 v[64:79], v[164:167], v[212:215], v[64:79]
    buffer_load_dwordx4 v129, s[28:31], s74 offen offset:1024  lds
    s_waitcnt vmcnt(20)
    ds_read_b64_tr_b16 v[160:161], v10 offset:49152
    ds_read_b64_tr_b16 v[162:163], v10 offset:50176
    ds_read_b64_tr_b16 v[164:165], v11 offset:49152
    ds_read_b64_tr_b16 v[166:167], v11 offset:50176
    s_waitcnt vmcnt(18) lgkmcnt(4)
    v_mfma_f32_32x32x16_bf16 v[16:31], v[168:171], v[216:219], v[16:31]
    s_add_u32 s69, s73, 18432
    buffer_load_dwordx4 v[192:195], v2, s[48:51], s69 offen sc1
    v_mfma_f32_32x32x16_bf16 v[32:47], v[172:175], v[216:219], v[32:47]
    buffer_load_dwordx4 v[196:199], v2, s[40:43], s69 offen sc1
    v_mfma_f32_32x32x16_bf16 v[48:63], v[168:171], v[220:223], v[48:63]
    s_add_u32 m0, s27, 32768
    s_add_u32 s74, s26, 327680
    buffer_load_dwordx4 v128, s[28:31], s74 offen offset:0  lds
    v_mfma_f32_32x32x16_bf16 v[64:79], v[172:175], v[220:223], v[64:79]
    buffer_load_dwordx4 v129, s[28:31], s74 offen offset:1024  lds
    s_waitcnt vmcnt(20)
    ds_read_b64_tr_b16 v[168:169], v10 offset:57344
    ds_read_b64_tr_b16 v[170:171], v10 offset:58368
    ds_read_b64_tr_b16 v[172:173], v11 offset:57344
    ds_read_b64_tr_b16 v[174:175], v11 offset:58368
    s_waitcnt vmcnt(18) lgkmcnt(4)
    v_mfma_f32_32x32x16_bf16 v[16:31], v[160:163], v[224:227], v[16:31]
    s_add_u32 s69, s73, 19456
    buffer_load_dwordx4 v[200:203], v2, s[48:51], s69 offen sc1
    v_mfma_f32_32x32x16_bf16 v[32:47], v[164:167], v[224:227], v[32:47]
    buffer_load_dwordx4 v[204:207], v2, s[40:43], s69 offen sc1
    v_mfma_f32_32x32x16_bf16 v[48:63], v[160:163], v[228:231], v[48:63]
    s_add_u32 m0, s27, 40960
    s_add_u32 s74, s26, 344064
    buffer_load_dwordx4 v128, s[28:31], s74 offen offset:0  lds
    v_mfma_f32_32x32x16_bf16 v[64:79], v[164:167], v[228:231], v[64:79]
    buffer_load_dwordx4 v129, s[28:31], s74 offen offset:1024  lds
    s_waitcnt vmcnt(20)
    ds_read_b64_tr_b16 v[160:161], v10 offset:0
    ds_read_b64_tr_b16 v[162:163], v10 offset:1024
    ds_read_b64_tr_b16 v[164:165], v11 offset:0
    ds_read_b64_tr_b16 v[166:167], v11 offset:1024
    s_waitcnt vmcnt(18) lgkmcnt(4)
    v_mfma_f32_32x32x16_bf16 v[16:31], v[168:171], v[232:235], v[16:31]
    s_add_u32 s69, s73, 20480
    buffer_load_dwordx4 v[208:211], v2, s[48:51], s69 offen sc1
    v_mfma_f32_32x32x16_bf16 v[32:47], v[172:175], v[232:235], v[32:47]
    buffer_load_dwordx4 v[212:215], v2, s[40:43], s69 offen sc1
    v_mfma_f32_32x32x16_bf16 v[48:63], v[168:171], v[236:239], v[48:63]
    v_mfma_f32_32x32x16_bf16 v[64:79], v[172:175], v[236:239], v[64:79]
    s_waitcnt vmcnt(18)
    ds_read_b64_tr_b16 v[168:169], v10 offset:8192
    ds_read_b64_tr_b16 v[170:171], v10 offset:9216
    ds_read_b64_tr_b16 v[172:173], v11 offset:8192
    ds_read_b64_tr_b16 v[174:175], v11 offset:9216
    s_waitcnt vmcnt(16) lgkmcnt(4)
    v_mfma_f32_32x32x16_bf16 v[16:31], v[160:163], v[176:179], v[16:31]
    s_add_u32 s69, s73, 21504
    buffer_load_dwordx4 v[216:219], v2, s[48:51], s69 offen sc1
    v_mfma_f32_32x32x16_bf16 v[32:47], v[164:167], v[176:179], v[32:47]
    buffer_load_dwordx4 v[220:223], v2, s[40:43], s69 offen sc1
    v_mfma_f32_32x32x16_bf16 v[48:63], v[160:163], v[180:183], v[48:63]
    v_mfma_f32_32x32x16_bf16 v[64:79], v[164:167], v[180:183], v[64:79]
    s_waitcnt vmcnt(16)
    ds_read_b64_tr_b16 v[160:161], v10 offset:16384
    ds_read_b64_tr_b16 v[162:163], v10 offset:17408
    ds_read_b64_tr_b16 v[164:165], v11 offset:16384
    ds_read_b64_tr_b16 v[166:167], v11 offset:17408
    s_waitcnt vmcnt(14) lgkmcnt(4)
    v_mfma_f32_32x32x16_bf16 v[16:31], v[168:171], v[184:187], v[16:31]
    v_mfma_f32_32x32x16_bf16 v[32:47], v[172:175], v[184:187], v[32:47]
    v_mfma_f32_32x32x16_bf16 v[48:63], v[168:171], v[188:191], v[48:63]
    v_mfma_f32_32x32x16_bf16 v[64:79], v[172:175], v[188:191], v[64:79]
    s_waitcnt vmcnt(12)
    ds_read_b64_tr_b16 v[168:169], v10 offset:24576
    ds_read_b64_tr_b16 v[170:171], v10 offset:25600
    ds_read_b64_tr_b16 v[172:173], v11 offset:24576
    ds_read_b64_tr_b16 v[174:175], v11 offset:25600
    s_waitcnt vmcnt(10) lgkmcnt(4)
    v_mfma_f32_32x32x16_bf16 v[16:31], v[160:163], v[192:195], v[16:31]
    v_mfma_f32_32x32x16_bf16 v[32:47], v[164:167], v[192:195], v[32:47]
    v_mfma_f32_32x32x16_bf16 v[48:63], v[160:163], v[196:199], v[48:63]
    v_mfma_f32_32x32x16_bf16 v[64:79], v[164:167], v[196:199], v[64:79]
    s_waitcnt vmcnt(8)
    ds_read_b64_tr_b16 v[160:161], v10 offset:32768
    ds_read_b64_tr_b16 v[162:163], v10 offset:33792
    ds_read_b64_tr_b16 v[164:165], v11 offset:32768
    ds_read_b64_tr_b16 v[166:167], v11 offset:33792
    s_waitcnt vmcnt(6) lgkmcnt(4)
    v_mfma_f32_32x32x16_bf16 v[16:31], v[168:171], v[200:203], v[16:31]
    v_mfma_f32_32x32x16_bf16 v[32:47], v[172:175], v[200:203], v[32:47]
    v_mfma_f32_32x32x16_bf16 v[48:63], v[168:171], v[204:207], v[48:63]
    v_mfma_f32_32x32x16_bf16 v[64:79], v[172:175], v[204:207], v[64:79]
    s_waitcnt vmcnt(4)
    ds_read_b64_tr_b16 v[168:169], v10 offset:40960
    ds_read_b64_tr_b16 v[170:171], v10 offset:41984
    ds_read_b64_tr_b16 v[172:173], v11 offset:40960
    ds_read_b64_tr_b16 v[174:175], v11 offset:41984
    s_waitcnt vmcnt(2) lgkmcnt(4)
    v_mfma_f32_32x32x16_bf16 v[16:31], v[160:163], v[208:211], v[16:31]
    v_mfma_f32_32x32x16_bf16 v[32:47], v[164:167], v[208:211], v[32:47]
    v_mfma_f32_32x32x16_bf16 v[48:63], v[160:163], v[212:215], v[48:63]
    v_mfma_f32_32x32x16_bf16 v[64:79], v[164:167], v[212:215], v[64:79]
    s_waitcnt vmcnt(0) lgkmcnt(0)
    s_mov_b64 exec, 1
    ds_add_u32 v12, v13 offset:72
    s_mov_b64 exec, -1
    ds_read_b32 v7, v12 offset:72
    v_mfma_f32_32x32x16_bf16 v[16:31], v[168:171], v[216:219], v[16:31]
    v_mfma_f32_32x32x16_bf16 v[32:47], v[172:175], v[216:219], v[32:47]
    v_mfma_f32_32x32x16_bf16 v[48:63], v[168:171], v[220:223], v[48:63]
    v_mfma_f32_32x32x16_bf16 v[64:79], v[172:175], v[220:223], v[64:79]
    s_mul_i32 s64, s57, 20480
    v_add_u32 v14, s64, v2
    s_waitcnt lgkmcnt(0)
    v_readfirstlane_b32 s67, v7
    s_cmp_ge_u32 s67, 4
    s_cbranch_scc1 L_syok_1022
    s_mov_b32 s66, 0
L_spin_1023:
    ds_read_b32 v7, v12 offset:72
    s_add_u32 s66, s66, 1
    s_cmp_gt_u32 s66, 400000
    s_cbranch_scc1 L_spinx_1024
    s_waitcnt lgkmcnt(0)
    v_readfirstlane_b32 s67, v7
    s_cmp_ge_u32 s67, 4
    s_cbranch_scc1 L_spinx_1024
    s_branch L_spin_1023
L_spinx_1024:
    s_waitcnt lgkmcnt(0)
L_syok_1022:
    ds_write_b128 v14, v[16:19] offset:0
    ds_write_b128 v14, v[20:23] offset:1024
    ds_write_b128 v14, v[24:27] offset:2048
    ds_write_b128 v14, v[28:31] offset:3072
    v_xor_b32 v15, 4096, v14
    ds_write_b128 v15, v[32:35] offset:0
    ds_write_b128 v15, v[36:39] offset:1024
    ds_write_b128 v15, v[40:43] offset:2048
    ds_write_b128 v15, v[44:47] offset:3072
    v_xor_b32 v15, 8192, v14
    ds_write_b128 v15, v[48:51] offset:0
    ds_write_b128 v15, v[52:55] offset:1024
    ds_write_b128 v15, v[56:59] offset:2048
    ds_write_b128 v15, v[60:63] offset:3072
    v_xor_b32 v15, 12288, v14
    ds_write_b128 v15, v[64:67] offset:0
    ds_write_b128 v15, v[68:71] offset:1024
    ds_write_b128 v15, v[72:75] offset:2048
    ds_write_b128 v15, v[76:79] offset:3072
    s_waitcnt lgkmcnt(0)
    s_barrier
    s_endpgm
L_A:
    s_waitcnt lgkmcnt(0)
    s_add_u32 s66, s24, 458752
    s_addc_u32 s67, s25, 0
    s_load_dword s61, s[66:67], 0
    s_mov_b32 s28, s4
    s_mov_b32 s29, s5
    s_mov_b32 s30, 2097152
    s_mov_b32 s31, 0x20000
    s_mov_b32 s32, s24
    s_mov_b32 s33, s25
    s_mov_b32 s34, 268435456
    s_mov_b32 s35, 0x20000
    s_lshl_b32 s64, s58, 4
    s_add_u32 s64, s64, s59
    s_lshl_b32 s64, s64, 2
    s_add_u32 s64, s64, s57
    s_lshl_b32 s74, s64, 1
    s_lshl_b32 s62, s74, 10
    v_lshlrev_b32 v2, 4, v0
    buffer_load_dwordx4 v[16:19], v2, s[28:31], s62 offen offset:0
    buffer_load_dwordx4 v[20:23], v2, s[28:31], s62 offen offset:1024
    s_lshr_b32 s64, s2, 3
    s_cmp_ge_u32 s64, 4
    s_cbranch_scc1 L_nopf_2001
    s_cmp_lg_u32 s56, 1
    s_cbranch_scc1 L_nopf_2001
    s_getpc_b64 s[52:53]
L_here_2002:
    s_sub_u32 s52, s52, L_here_2002-parallel_sum__sliding_block__mixer_channel_mlp__prompt_kernel
    s_subb_u32 s53, s53, 0
    s_lshl_b32 s64, s64, 13
    v_lshlrev_b32 v3, 7, v0
    v_add_u32 v3, s64, v3
    v_min_u32 v3, L_attn_slow-parallel_sum__sliding_block__mixer_channel_mlp__prompt_kernel, v3
    global_load_dword v1, v3, s[52:53]
L_nopf_2001:
    v_lshrrev_b32 v4, 5, v0
    v_lshlrev_b32 v4, 3, v4
    v_bfe_u32 v5, v0, 2, 2
    v_add_u32 v4, v4, v5
    v_mul_u32_u24 v5, 192, v4
    v_bfe_u32 v4, v0, 4, 1
    v_lshl_add_u32 v5, v4, 5, v5
    v_and_b32 v4, 3, v0
    v_lshl_add_u32 v5, v4, 3, v5
    v_and_b32 v6, 31, v0
    v_lshlrev_b32 v6, 7, v6
    s_lshl_b32 s64, s57, 12
    v_add_u32 v6, s64, v6
    v_lshrrev_b32 v4, 5, v0
    v_bfe_u32 v7, v0, 1, 3
    v_xor_b32 v7, v7, v4
    s_xor_b32 s65, s57, 0
    s_lshl_b32 s64, s65, 1
    v_xor_b32 v4, s64, v7
    v_lshl_add_u32 v136, v4, 4, v6
    s_mul_i32 s64, s65, 3072
    s_add_u32 s64, s64, 65536
    v_add_u32 v140, s64, v5
    s_xor_b32 s65, s57, 1
    s_lshl_b32 s64, s65, 1
    v_xor_b32 v4, s64, v7
    v_lshl_add_u32 v137, v4, 4, v6
    s_mul_i32 s64, s65, 3072
    s_add_u32 s64, s64, 65536
    v_add_u32 v141, s64, v5
    s_xor_b32 s65, s57, 2
    s_lshl_b32 s64, s65, 1
    v_xor_b32 v4, s64, v7
    v_lshl_add_u32 v138, v4, 4, v6
    s_mul_i32 s64, s65, 3072
    s_add_u32 s64, s64, 65536
    v_add_u32 v142, s64, v5
    s_xor_b32 s65, s57, 3
    s_lshl_b32 s64, s65, 1
    v_xor_b32 v4, s64, v7
    v_lshl_add_u32 v139, v4, 4, v6
    s_mul_i32 s64, s65, 3072
    s_add_u32 s64, s64, 65536
    v_add_u32 v143, s64, v5
    v_bfe_u32 v5, v0, 4, 1
    v_and_b32 v7, 15, v0
    v_cmp_eq_u32 vcc, v5, v7
    v_mov_b32 v5, 0x3f803f80
    s_nop 0
    v_cndmask_b32 v248, 0, v5, vcc
    v_mov_b32 v249, v248
    v_mov_b32 v250, v248
    v_mov_b32 v251, v248
    s_mul_i32 s64, s57, 768
    s_add_u32 s64, s64, 147456
    v_lshlrev_b32 v8, 2, v0
    v_and_b32 v9, 124, v8
    v_add_u32 v8, s64, v8
    v_add_u32 v9, 147456, v9
    s_lshr_b32 s10, s2, 3
    s_and_b32 s11, s2, 7
    s_lshl_b32 s75, s10, 1
    v_and_b32 v3, 27, v0
    v_cmp_eq_u32 vcc, 16, v3
    v_mov_b32 v4, 0x3f803f80
    s_nop 0
    v_cndmask_b32 v4, 0, v4, vcc
    s_add_i32 s64, s75, -8
    s_cmp_ge_i32 s64, 0
    s_cselect_b32 s64, -1, 0
    v_and_b32 v6, s64, v4
    v_mov_b32 v7, v6
    v_mov_b64 v[56:57], v[6:7]
    v_mov_b64 v[58:59], v[6:7]
    v_mov_b64 v[60:61], v[6:7]
    v_mov_b64 v[62:63], v[6:7]
    v_mov_b64 v[64:65], v[6:7]
    v_mov_b64 v[66:67], v[6:7]
    v_mov_b64 v[68:69], v[6:7]
    v_mov_b64 v[70:71], v[6:7]
    s_add_i32 s64, s75, -6
    s_cmp_ge_i32 s64, 0
    s_cselect_b32 s64, -1, 0
    v_and_b32 v6, s64, v4
    v_mov_b32 v7, v6
    v_mov_b64 v[72:73], v[6:7]
    v_mov_b64 v[74:75], v[6:7]
    v_mov_b64 v[76:77], v[6:7]
    v_mov_b64 v[78:79], v[6:7]
    v_mov_b64 v[80:81], v[6:7]
    v_mov_b64 v[82:83], v[6:7]
    v_mov_b64 v[84:85], v[6:7]
    v_mov_b64 v[86:87], v[6:7]
    s_add_i32 s64, s75, -4
    s_cmp_ge_i32 s64, 0
    s_cselect_b32 s64, -1, 0
    v_and_b32 v6, s64, v4
    v_mov_b32 v7, v6
    v_mov_b64 v[88:89], v[6:7]
    v_mov_b64 v[90:91], v[6:7]
    v_mov_b64 v[92:93], v[6:7]
    v_mov_b64 v[94:95], v[6:7]
    v_mov_b64 v[96:97], v[6:7]
    v_mov_b64 v[98:99], v[6:7]
    v_mov_b64 v[100:101], v[6:7]
    v_mov_b64 v[102:103], v[6:7]
    s_add_i32 s64, s75, -2
    s_cmp_ge_i32 s64, 0
    s_cselect_b32 s64, -1, 0
    v_and_b32 v6, s64, v4
    v_mov_b32 v7, v6
    v_mov_b64 v[104:105], v[6:7]
    v_mov_b64 v[106:107], v[6:7]
    v_mov_b64 v[108:109], v[6:7]
    v_mov_b64 v[110:111], v[6:7]
    v_mov_b64 v[112:113], v[6:7]
    v_mov_b64 v[114:115], v[6:7]
    v_mov_b64 v[116:117], v[6:7]
    v_mov_b64 v[118:119], v[6:7]
    v_mov_b32 v6, v4
    v_mov_b32 v7, v4
    v_mov_b64 v[120:121], v[6:7]
    v_mov_b64 v[122:123], v[6:7]
    v_mov_b64 v[124:125], v[6:7]
    v_mov_b64 v[126:127], v[6:7]
    v_mov_b64 v[128:129], v[6:7]
    v_mov_b64 v[130:131], v[6:7]
    v_mov_b64 v[132:133], v[6:7]
    v_mov_b64 v[134:135], v[6:7]
    v_and_b32 v5, 31, v0
    v_lshrrev_b32 v6, 5, v0
    v_lshlrev_b32 v6, 2, v6
    v_sub_u32 v5, v5, v6
    v_mov_b32 v6, 0xff800000
    v_cmp_le_i32 vcc, 0, v5
    s_nop 1
    v_cndmask_b32_e64 v144, v6, 0, vcc
    v_cndmask_b32_e64 v160, 0, v6, vcc
    v_cmp_le_i32 vcc, 1, v5
    s_nop 1
    v_cndmask_b32_e64 v145, v6, 0, vcc
    v_cndmask_b32_e64 v161, 0, v6, vcc
    v_cmp_le_i32 vcc, 2, v5
    s_nop 1
    v_cndmask_b32_e64 v146, v6, 0, vcc
    v_cndmask_b32_e64 v162, 0, v6, vcc
    v_cmp_le_i32 vcc, 3, v5
    s_nop 1
    v_cndmask_b32_e64 v147, v6, 0, vcc
    v_cndmask_b32_e64 v163, 0, v6, vcc
    v_cmp_le_i32 vcc, 8, v5
    s_nop 1
    v_cndmask_b32_e64 v148, v6, 0, vcc
    v_cndmask_b32_e64 v164, 0, v6, vcc
    v_cmp_le_i32 vcc, 9, v5
    s_nop 1
    v_cndmask_b32_e64 v149, v6, 0, vcc
    v_cndmask_b32_e64 v165, 0, v6, vcc
    v_cmp_le_i32 vcc, 10, v5
    s_nop 1
    v_cndmask_b32_e64 v150, v6, 0, vcc
    v_cndmask_b32_e64 v166, 0, v6, vcc
    v_cmp_le_i32 vcc, 11, v5
    s_nop 1
    v_cndmask_b32_e64 v151, v6, 0, vcc
    v_cndmask_b32_e64 v167, 0, v6, vcc
    v_cmp_le_i32 vcc, 16, v5
    s_nop 1
    v_cndmask_b32_e64 v152, v6, 0, vcc
    v_cndmask_b32_e64 v168, 0, v6, vcc
    v_cmp_le_i32 vcc, 17, v5
    s_nop 1
    v_cndmask_b32_e64 v153, v6, 0, vcc
    v_cndmask_b32_e64 v169, 0, v6, vcc
    v_cmp_le_i32 vcc, 18, v5
    s_nop 1
    v_cndmask_b32_e64 v154, v6, 0, vcc
    v_cndmask_b32_e64 v170, 0, v6, vcc
    v_cmp_le_i32 vcc, 19, v5
    s_nop 1
    v_cndmask_b32_e64 v155, v6, 0, vcc
    v_cndmask_b32_e64 v171, 0, v6, vcc
    v_cmp_le_i32 vcc, 24, v5
    s_nop 1
    v_cndmask_b32_e64 v156, v6, 0, vcc
    v_cndmask_b32_e64 v172, 0, v6, vcc
    v_cmp_le_i32 vcc, 25, v5
    s_nop 1
    v_cndmask_b32_e64 v157, v6, 0, vcc
    v_cndmask_b32_e64 v173, 0, v6, vcc
    v_cmp_le_i32 vcc, 26, v5
    s_nop 1
    v_cndmask_b32_e64 v158, v6, 0, vcc
    v_cndmask_b32_e64 v174, 0, v6, vcc
    v_cmp_le_i32 vcc, 27, v5
    s_nop 1
    v_cndmask_b32_e64 v159, v6, 0, vcc
    v_cndmask_b32_e64 v175, 0, v6, vcc
    s_waitcnt lgkmcnt(0)
    s_mul_i32 s61, s61, 0x9e3779b1
    s_add_u32 s61, s61, 0x7f4a7c15
    s_waitcnt vmcnt(0)
    s_mov_b32 s62, 0x3f803f80
    v_dot2_f32_bf16 v4, v16, s62, 0
    v_dot2_f32_bf16 v5, v16, v16, 0
    v_dot2_f32_bf16 v4, v17, s62, v4
    v_dot2_f32_bf16 v5, v17, v17, v5
    v_dot2_f32_bf16 v4, v18, s62, v4
    v_dot2_f32_bf16 v5, v18, v18, v5
    v_dot2_f32_bf16 v4, v19, s62, v4
    v_dot2_f32_bf16 v5, v19, v19, v5
    v_dot2_f32_bf16 v6, v20, s62, 0
    v_dot2_f32_bf16 v7, v20, v20, 0
    v_dot2_f32_bf16 v6, v21, s62, v6
    v_dot2_f32_bf16 v7, v21, v21, v7
    v_dot2_f32_bf16 v6, v22, s62, v6
    v_dot2_f32_bf16 v7, v22, v22, v7
    v_dot2_f32_bf16 v6, v23, s62, v6
    v_dot2_f32_bf16 v7, v23, v23, v7
    v_add_f32_dpp v4, v4, v4 row_shr:1 row_mask:0xf bank_mask:0xf bound_ctrl:0
    v_add_f32_dpp v5, v5, v5 row_shr:1 row_mask:0xf bank_mask:0xf bound_ctrl:0
    v_add_f32_dpp v6, v6, v6 row_shr:1 row_mask:0xf bank_mask:0xf bound_ctrl:0
    v_add_f32_dpp v7, v7, v7 row_shr:1 row_mask:0xf bank_mask:0xf bound_ctrl:0
    v_add_f32_dpp v4, v4, v4 row_shr:2 row_mask:0xf bank_mask:0xf bound_ctrl:0
    v_add_f32_dpp v5, v5, v5 row_shr:2 row_mask:0xf bank_mask:0xf bound_ctrl:0
    v_add_f32_dpp v6, v6, v6 row_shr:2 row_mask:0xf bank_mask:0xf bound_ctrl:0
    v_add_f32_dpp v7, v7, v7 row_shr:2 row_mask:0xf bank_mask:0xf bound_ctrl:0
    v_add_f32_dpp v4, v4, v4 row_shr:4 row_mask:0xf bank_mask:0xf bound_ctrl:0
    v_add_f32_dpp v5, v5, v5 row_shr:4 row_mask:0xf bank_mask:0xf bound_ctrl:0
    v_add_f32_dpp v6, v6, v6 row_shr:4 row_mask:0xf bank_mask:0xf bound_ctrl:0
    v_add_f32_dpp v7, v7, v7 row_shr:4 row_mask:0xf bank_mask:0xf bound_ctrl:0
    v_add_f32_dpp v4, v4, v4 row_shr:8 row_mask:0xf bank_mask:0xf bound_ctrl:0
    v_add_f32_dpp v5, v5, v5 row_shr:8 row_mask:0xf bank_mask:0xf bound_ctrl:0
    v_add_f32_dpp v6, v6, v6 row_shr:8 row_mask:0xf bank_mask:0xf bound_ctrl:0
    v_add_f32_dpp v7, v7, v7 row_shr:8 row_mask:0xf bank_mask:0xf bound_ctrl:0
    v_add_f32_dpp v4, v4, v4 row_bcast:15 row_mask:0xa bank_mask:0xf
    v_add_f32_dpp v5, v5, v5 row_bcast:15 row_mask:0xa bank_mask:0xf
    v_add_f32_dpp v6, v6, v6 row_bcast:15 row_mask:0xa bank_mask:0xf
    v_add_f32_dpp v7, v7, v7 row_bcast:15 row_mask:0xa bank_mask:0xf
    v_add_f32_dpp v4, v4, v4 row_bcast:31 row_mask:0xc bank_mask:0xf
    v_add_f32_dpp v5, v5, v5 row_bcast:31 row_mask:0xc bank_mask:0xf
    v_add_f32_dpp v6, v6, v6 row_bcast:31 row_mask:0xc bank_mask:0xf
    v_add_f32_dpp v7, v7, v7 row_bcast:31 row_mask:0xc bank_mask:0xf
    v_mul_f32 v16, 0x3b000000, v4
    v_mul_f32 v4, v16, v16
    v_mul_f32 v5, 0x3b000000, v5
    v_sub_f32 v5, v5, v4
    v_max_f32 v5, 0, v5
    v_add_f32 v5, 0x3727c5ac, v5
    v_rsq_f32 v18, v5
    v_mov_b32 v17, s61
    v_mov_b32 v19, s61
    v_mul_f32 v20, 0x3b000000, v6
    v_mul_f32 v6, v20, v20
    v_mul_f32 v7, 0x3b000000, v7
    v_sub_f32 v7, v7, v6
    v_max_f32 v7, 0, v7
    v_add_f32 v7, 0x3727c5ac, v7
    v_rsq_f32 v22, v7
    v_mov_b32 v21, s61
    v_mov_b32 v23, s61
    s_lshl_b32 s62, s74, 4
    s_add_u32 s62, s62, 393216
    v_mov_b32 v4, 0
    s_mov_b32 exec_lo, 0
    s_mov_b32 exec_hi, 0x80000000
    buffer_store_dwordx4 v[16:19], v4, s[32:35], s62 offen offset:0 sc1
    buffer_store_dwordx4 v[20:23], v4, s[32:35], s62 offen offset:16 sc1
    s_cmp_lg_u32 s56, 2
    s_cbranch_scc1 L_nocnt_2003
    s_mov_b32 s52, s22
    s_mov_b32 s53, s23
    s_mov_b32 s54, 256
    s_mov_b32 s55, 0x20000
    v_mov_b32 v5, 1
    s_and_b32 s64, s2, 1
    s_lshl_b32 s64, s64, 7
    buffer_atomic_add v5, v4, s[52:55], s64 offen
L_nocnt_2003:
    s_mov_b64 exec, -1
    s_mul_i32 s64, s57, 2304
    s_add_u32 s64, s64, 151552
    v_and_b32 v4, 31, v0
    v_mul_u32_u24 v4, 72, v4
    v_lshrrev_b32 v5, 5, v0
    v_lshl_add_u32 v4, v5, 3, v4
    v_add_u32 v4, s64, v4
    v_lshlrev_b32 v6, 2, v5
    v_bfe_u32 v7, v0, 2, 2
    v_add_u32 v6, v6, v7
    v_mul_u32_u24 v6, 72, v6
    v_bfe_u32 v7, v0, 4, 1
    v_lshl_add_u32 v6, v7, 5, v6
    v_and_b32 v13, 3, v0
    v_lshl_add_u32 v6, v13, 3, v6
    v_add_u32 v6, s64, v6
    v_lshlrev_b32 v7, 16, v7
    v_lshl_add_u32 v7, v5, 8, v7
    v_and_b32 v13, 15, v0
    v_lshl_add_u32 v7, v13, 4, v7
    s_barrier
    ds_read_b128 v[224:227], v136 offset:0
    ds_read_b64_tr_b16 v[16:17], v140 offset:0
    ds_read_b64_tr_b16 v[18:19], v140 offset:768
    ds_read_b64_tr_b16 v[20:21], v140 offset:64
    ds_read_b64_tr_b16 v[22:23], v140 offset:832
    ds_read_b64_tr_b16 v[24:25], v140 offset:128
    ds_read_b64_tr_b16 v[26:27], v140 offset:896
    ds_read_b128 v[228:231], v137 offset:0
    ds_read_b64_tr_b16 v[28:29], v141 offset:0
    ds_read_b64_tr_b16 v[30:31], v141 offset:768
    ds_read_b64_tr_b16 v[32:33], v141 offset:64
    ds_read_b64_tr_b16 v[34:35], v141 offset:832
    ds_read_b64_tr_b16 v[36:37], v141 offset:128
    ds_read_b64_tr_b16 v[38:39], v141 offset:896
    s_waitcnt lgkmcnt(7)
    v_mfma_f32_32x32x16_bf16 v[176:191], v[16:19], v[224:227], 0
    ds_read_b128 v[232:235], v138 offset:0
    ds_read_b64_tr_b16 v[40:41], v142 offset:0
    ds_read_b64_tr_b16 v[42:43], v142 offset:768
    v_mfma_f32_16x16x32_bf16 v[236:239], v[248:251], v[16:19], 0
    v_mfma_f32_32x32x16_bf16 v[192:207], v[20:23], v[224:227], 0
    ds_read_b64_tr_b16 v[44:45], v142 offset:64
    ds_read_b64_tr_b16 v[46:47], v142 offset:832
    v_mfma_f32_16x16x32_bf16 v[240:243], v[248:251], v[20:23], 0
    v_mfma_f32_32x32x16_bf16 v[208:223], v[24:27], v[224:227], 0
    ds_read_b64_tr_b16 v[48:49], v142 offset:128
    ds_read_b64_tr_b16 v[50:51], v142 offset:896
    v_mfma_f32_16x16x32_bf16 v[244:247], v[248:251], v[24:27], 0
    s_waitcnt lgkmcnt(7)
    v_mfma_f32_32x32x16_bf16 v[176:191], v[28:31], v[228:231], v[176:191]
    ds_read_b128 v[224:227], v139 offset:0
    ds_read_b64_tr_b16 v[16:17], v143 offset:0
    ds_read_b64_tr_b16 v[18:19], v143 offset:768
    v_mfma_f32_32x32x16_bf16 v[192:207], v[32:35], v[228:231], v[192:207]
    ds_read_b64_tr_b16 v[20:21], v143 offset:64
    ds_read_b64_tr_b16 v[22:23], v143 offset:832
    v_mfma_f32_32x32x16_bf16 v[208:223], v[36:39], v[228:231], v[208:223]
    ds_read_b64_tr_b16 v[24:25], v143 offset:128
    ds_read_b64_tr_b16 v[26:27], v143 offset:896
    s_barrier
    s_waitcnt lgkmcnt(7)
    v_mfma_f32_32x32x16_bf16 v[176:191], v[40:43], v[232:235], v[176:191]
    ds_read_b128 v[228:231], v136 offset:16384
    ds_read_b64_tr_b16 v[28:29], v140 offset:12288
    ds_read_b64_tr_b16 v[30:31], v140 offset:13056
    v_mfma_f32_32x32x16_bf16 v[192:207], v[44:47], v[232:235], v[192:207]
    ds_read_b64_tr_b16 v[32:33], v140 offset:12352
    ds_read_b64_tr_b16 v[34:35], v140 offset:13120
    v_mfma_f32_32x32x16_bf16 v[208:223], v[48:51], v[232:235], v[208:223]
    ds_read_b64_tr_b16 v[36:37], v140 offset:12416
    ds_read_b64_tr_b16 v[38:39], v140 offset:13184
    s_waitcnt lgkmcnt(7)
    v_mfma_f32_32x32x16_bf16 v[176:191], v[16:19], v[224:227], v[176:191]
    ds_read_b128 v[232:235], v137 offset:16384
    ds_read_b64_tr_b16 v[40:41], v141 offset:12288
    ds_read_b64_tr_b16 v[42:43], v141 offset:13056
    v_mfma_f32_32x32x16_bf16 v[192:207], v[20:23], v[224:227], v[192:207]
    ds_read_b64_tr_b16 v[44:45], v141 offset:12352
    ds_read_b64_tr_b16 v[46:47], v141 offset:13120
    v_mfma_f32_32x32x16_bf16 v[208:223], v[24:27], v[224:227], v[208:223]
    ds_read_b64_tr_b16 v[48:49], v141 offset:12416
    ds_read_b64_tr_b16 v[50:51], v141 offset:13184
    s_waitcnt lgkmcnt(7)
    v_mfma_f32_32x32x16_bf16 v[176:191], v[28:31], v[228:231], v[176:191]
    ds_read_b128 v[224:227], v138 offset:16384
    ds_read_b64_tr_b16 v[16:17], v142 offset:12288
    ds_read_b64_tr_b16 v[18:19], v142 offset:13056
    v_mfma_f32_16x16x32_bf16 v[236:239], v[248:251], v[28:31], v[236:239]
    v_mfma_f32_32x32x16_bf16 v[192:207], v[32:35], v[228:231], v[192:207]
    ds_read_b64_tr_b16 v[20:21], v142 offset:12352
    ds_read_b64_tr_b16 v[22:23], v142 offset:13120
    v_mfma_f32_16x16x32_bf16 v[240:243], v[248:251], v[32:35], v[240:243]
    v_mfma_f32_32x32x16_bf16 v[208:223], v[36:39], v[228:231], v[208:223]
    ds_read_b64_tr_b16 v[24:25], v142 offset:12416
    ds_read_b64_tr_b16 v[26:27], v142 offset:13184
    v_mfma_f32_16x16x32_bf16 v[244:247], v[248:251], v[36:39], v[244:247]
    s_waitcnt lgkmcnt(7)
    v_mfma_f32_32x32x16_bf16 v[176:191], v[40:43], v[232:235], v[176:191]
    ds_read_b128 v[228:231], v139 offset:16384
    ds_read_b64_tr_b16 v[28:29], v143 offset:12288
    ds_read_b64_tr_b16 v[30:31], v143 offset:13056
    v_mfma_f32_32x32x16_bf16 v[192:207], v[44:47], v[232:235], v[192:207]
    ds_read_b64_tr_b16 v[32:33], v143 offset:12352
    ds_read_b64_tr_b16 v[34:35], v143 offset:13120
    v_mfma_f32_32x32x16_bf16 v[208:223], v[48:51], v[232:235], v[208:223]
    ds_read_b64_tr_b16 v[36:37], v143 offset:12416
    ds_read_b64_tr_b16 v[38:39], v143 offset:13184
    s_barrier
    s_waitcnt lgkmcnt(7)
    v_mfma_f32_32x32x16_bf16 v[176:191], v[16:19], v[224:227], v[176:191]
    ds_read_b128 v[232:235], v136 offset:32768
    ds_read_b64_tr_b16 v[40:41], v140 offset:24576
    ds_read_b64_tr_b16 v[42:43], v140 offset:25344
    v_mfma_f32_32x32x16_bf16 v[192:207], v[20:23], v[224:227], v[192:207]
    ds_read_b64_tr_b16 v[44:45], v140 offset:24640
    ds_read_b64_tr_b16 v[46:47], v140 offset:25408
    v_mfma_f32_32x32x16_bf16 v[208:223], v[24:27], v[224:227], v[208:223]
    ds_read_b64_tr_b16 v[48:49], v140 offset:24704
    ds_read_b64_tr_b16 v[50:51], v140 offset:25472
    s_waitcnt lgkmcnt(7)
    v_mfma_f32_32x32x16_bf16 v[176:191], v[28:31], v[228:231], v[176:191]
    ds_read_b128 v[224:227], v137 offset:32768
    ds_read_b64_tr_b16 v[16:17], v141 offset:24576
    ds_read_b64_tr_b16 v[18:19], v141 offset:25344
    v_mfma_f32_32x32x16_bf16 v[192:207], v[32:35], v[228:231], v[192:207]
    ds_read_b64_tr_b16 v[20:21], v141 offset:24640
    ds_read_b64_tr_b16 v[22:23], v141 offset:25408
    v_mfma_f32_32x32x16_bf16 v[208:223], v[36:39], v[228:231], v[208:223]
    ds_read_b64_tr_b16 v[24:25], v141 offset:24704
    ds_read_b64_tr_b16 v[26:27], v141 offset:25472
    s_waitcnt lgkmcnt(7)
    v_mfma_f32_32x32x16_bf16 v[176:191], v[40:43], v[232:235], v[176:191]
    ds_read_b128 v[228:231], v138 offset:32768
    ds_read_b64_tr_b16 v[28:29], v142 offset:24576
    ds_read_b64_tr_b16 v[30:31], v142 offset:25344
    v_mfma_f32_16x16x32_bf16 v[236:239], v[248:251], v[40:43], v[236:239]
    v_mfma_f32_32x32x16_bf16 v[192:207], v[44:47], v[232:235], v[192:207]
    ds_read_b64_tr_b16 v[32:33], v142 offset:24640
    ds_read_b64_tr_b16 v[34:35], v142 offset:25408
    v_mfma_f32_16x16x32_bf16 v[240:243], v[248:251], v[44:47], v[240:243]
    v_mfma_f32_32x32x16_bf16 v[208:223], v[48:51], v[232:235], v[208:223]
    ds_read_b64_tr_b16 v[36:37], v142 offset:24704
    ds_read_b64_tr_b16 v[38:39], v142 offset:25472
    v_mfma_f32_16x16x32_bf16 v[244:247], v[248:251], v[48:51], v[244:247]
    s_waitcnt lgkmcnt(7)
    v_mfma_f32_32x32x16_bf16 v[176:191], v[16:19], v[224:227], v[176:191]
    ds_read_b128 v[232:235], v139 offset:32768
    ds_read_b64_tr_b16 v[40:41], v143 offset:24576
    ds_read_b64_tr_b16 v[42:43], v143 offset:25344
    v_mfma_f32_32x32x16_bf16 v[192:207], v[20:23], v[224:227], v[192:207]
    ds_read_b64_tr_b16 v[44:45], v143 offset:24640
    ds_read_b64_tr_b16 v[46:47], v143 offset:25408
    v_mfma_f32_32x32x16_bf16 v[208:223], v[24:27], v[224:227], v[208:223]
    ds_read_b64_tr_b16 v[48:49], v143 offset:24704
    ds_read_b64_tr_b16 v[50:51], v143 offset:25472
    s_barrier
    s_waitcnt lgkmcnt(7)
    v_mfma_f32_32x32x16_bf16 v[176:191], v[28:31], v[228:231], v[176:191]
    ds_read_b128 v[224:227], v136 offset:49152
    ds_read_b64_tr_b16 v[16:17], v140 offset:36864
    ds_read_b64_tr_b16 v[18:19], v140 offset:37632
    v_mfma_f32_32x32x16_bf16 v[192:207], v[32:35], v[228:231], v[192:207]
    ds_read_b64_tr_b16 v[20:21], v140 offset:36928
    ds_read_b64_tr_b16 v[22:23], v140 offset:37696
    v_mfma_f32_32x32x16_bf16 v[208:223], v[36:39], v[228:231], v[208:223]
    ds_read_b64_tr_b16 v[24:25], v140 offset:36992
    ds_read_b64_tr_b16 v[26:27], v140 offset:37760
    s_waitcnt lgkmcnt(7)
    v_mfma_f32_32x32x16_bf16 v[176:191], v[40:43], v[232:235], v[176:191]
    ds_read_b128 v[228:231], v137 offset:49152
    ds_read_b64_tr_b16 v[28:29], v141 offset:36864
    ds_read_b64_tr_b16 v[30:31], v141 offset:37632
    v_mfma_f32_32x32x16_bf16 v[192:207], v[44:47], v[232:235], v[192:207]
    ds_read_b64_tr_b16 v[32:33], v141 offset:36928
    ds_read_b64_tr_b16 v[34:35], v141 offset:37696
    v_mfma_f32_32x32x16_bf16 v[208:223], v[48:51], v[232:235], v[208:223]
    ds_read_b64_tr_b16 v[36:37], v141 offset:36992
    ds_read_b64_tr_b16 v[38:39], v141 offset:37760
    s_waitcnt lgkmcnt(7)
    v_mfma_f32_32x32x16_bf16 v[176:191], v[16:19], v[224:227], v[176:191]
    ds_read_b128 v[232:235], v138 offset:49152
    ds_read_b64_tr_b16 v[40:41], v142 offset:36864
    ds_read_b64_tr_b16 v[42:43], v142 offset:37632
    v_mfma_f32_16x16x32_bf16 v[236:239], v[248:251], v[16:19], v[236:239]
    v_mfma_f32_32x32x16_bf16 v[192:207], v[20:23], v[224:227], v[192:207]
    ds_read_b64_tr_b16 v[44:45], v142 offset:36928
    ds_read_b64_tr_b16 v[46:47], v142 offset:37696
    v_mfma_f32_16x16x32_bf16 v[240:243], v[248:251], v[20:23], v[240:243]
    v_mfma_f32_32x32x16_bf16 v[208:223], v[24:27], v[224:227], v[208:223]
    ds_read_b64_tr_b16 v[48:49], v142 offset:36992
    ds_read_b64_tr_b16 v[50:51], v142 offset:37760
    v_mfma_f32_16x16x32_bf16 v[244:247], v[248:251], v[24:27], v[244:247]
    s_waitcnt lgkmcnt(7)
    v_mfma_f32_32x32x16_bf16 v[176:191], v[28:31], v[228:231], v[176:191]
    ds_read_b128 v[224:227], v139 offset:49152
    ds_read_b64_tr_b16 v[16:17], v143 offset:36864
    ds_read_b64_tr_b16 v[18:19], v143 offset:37632
    v_mfma_f32_32x32x16_bf16 v[192:207], v[32:35], v[228:231], v[192:207]
    ds_read_b64_tr_b16 v[20:21], v143 offset:36928
    ds_read_b64_tr_b16 v[22:23], v143 offset:37696
    v_mfma_f32_32x32x16_bf16 v[208:223], v[36:39], v[228:231], v[208:223]
    ds_read_b64_tr_b16 v[24:25], v143 offset:36992
    ds_read_b64_tr_b16 v[26:27], v143 offset:37760
    s_barrier
    s_waitcnt lgkmcnt(7)
    v_mfma_f32_32x32x16_bf16 v[176:191], v[40:43], v[232:235], v[176:191]
    ds_read_b128 v[228:231], v136 offset:0
    ds_read_b64_tr_b16 v[28:29], v140 offset:0
    ds_read_b64_tr_b16 v[30:31], v140 offset:768
    v_mfma_f32_32x32x16_bf16 v[192:207], v[44:47], v[232:235], v[192:207]
    ds_read_b64_tr_b16 v[32:33], v140 offset:64
    ds_read_b64_tr_b16 v[34:35], v140 offset:832
    v_mfma_f32_32x32x16_bf16 v[208:223], v[48:51], v[232:235], v[208:223]
    ds_read_b64_tr_b16 v[36:37], v140 offset:128
    ds_read_b64_tr_b16 v[38:39], v140 offset:896
    s_waitcnt lgkmcnt(7)
    v_mfma_f32_32x32x16_bf16 v[176:191], v[16:19], v[224:227], v[176:191]
    ds_read_b128 v[232:235], v137 offset:0
    ds_read_b64_tr_b16 v[40:41], v141 offset:0
    ds_read_b64_tr_b16 v[42:43], v141 offset:768
    v_mfma_f32_32x32x16_bf16 v[192:207], v[20:23], v[224:227], v[192:207]
    ds_read_b64_tr_b16 v[44:45], v141 offset:64
    ds_read_b64_tr_b16 v[46:47], v141 offset:832
    v_mfma_f32_32x32x16_bf16 v[208:223], v[24:27], v[224:227], v[208:223]
    ds_read_b64_tr_b16 v[48:49], v141 offset:128
    ds_read_b64_tr_b16 v[50:51], v141 offset:896
    s_waitcnt lgkmcnt(7)
    v_mfma_f32_32x32x16_bf16 v[176:191], v[28:31], v[228:231], v[176:191]
    ds_read_b128 v[224:227], v138 offset:0
    ds_read_b64_tr_b16 v[16:17], v142 offset:0
    ds_read_b64_tr_b16 v[18:19], v142 offset:768
    v_mfma_f32_16x16x32_bf16 v[236:239], v[248:251], v[28:31], v[236:239]
    v_mfma_f32_32x32x16_bf16 v[192:207], v[32:35], v[228:231], v[192:207]
    ds_read_b64_tr_b16 v[20:21], v142 offset:64
    ds_read_b64_tr_b16 v[22:23], v142 offset:832
    v_mfma_f32_16x16x32_bf16 v[240:243], v[248:251], v[32:35], v[240:243]
    v_mfma_f32_32x32x16_bf16 v[208:223], v[36:39], v[228:231], v[208:223]
    ds_read_b64_tr_b16 v[24:25], v142 offset:128
    ds_read_b64_tr_b16 v[26:27], v142 offset:896
    v_mfma_f32_16x16x32_bf16 v[244:247], v[248:251], v[36:39], v[244:247]
    s_waitcnt lgkmcnt(7)
    v_mfma_f32_32x32x16_bf16 v[176:191], v[40:43], v[232:235], v[176:191]
    ds_read_b128 v[228:231], v139 offset:0
    ds_read_b64_tr_b16 v[28:29], v143 offset:0
    ds_read_b64_tr_b16 v[30:31], v143 offset:768
    v_mfma_f32_32x32x16_bf16 v[192:207], v[44:47], v[232:235], v[192:207]
    ds_read_b64_tr_b16 v[32:33], v143 offset:64
    ds_read_b64_tr_b16 v[34:35], v143 offset:832
    v_mfma_f32_32x32x16_bf16 v[208:223], v[48:51], v[232:235], v[208:223]
    ds_read_b64_tr_b16 v[36:37], v143 offset:128
    ds_read_b64_tr_b16 v[38:39], v143 offset:896
    s_barrier
    v_and_b32 v10, 31, v0
    s_lshl_b32 s64, s72, 5
    v_add_u32 v10, s64, v10
    v_lshlrev_b32 v10, 4, v10
    v_add_u32 v10, 393216, v10
    buffer_load_dwordx4 v[252:255], v10, s[32:35], 0 offen sc1
    s_waitcnt lgkmcnt(7)
    v_mfma_f32_32x32x16_bf16 v[176:191], v[16:19], v[224:227], v[176:191]
    ds_read_b128 v[232:235], v136 offset:16384
    ds_read_b64_tr_b16 v[40:41], v140 offset:12288
    ds_read_b64_tr_b16 v[42:43], v140 offset:13056
    v_mfma_f32_32x32x16_bf16 v[192:207], v[20:23], v[224:227], v[192:207]
    ds_read_b64_tr_b16 v[44:45], v140 offset:12352
    ds_read_b64_tr_b16 v[46:47], v140 offset:13120
    v_mfma_f32_32x32x16_bf16 v[208:223], v[24:27], v[224:227], v[208:223]
    ds_read_b64_tr_b16 v[48:49], v140 offset:12416
    ds_read_b64_tr_b16 v[50:51], v140 offset:13184
    s_waitcnt lgkmcnt(7)
    v_mfma_f32_32x32x16_bf16 v[176:191], v[28:31], v[228:231], v[176:191]
    ds_read_b128 v[224:227], v137 offset:16384
    ds_read_b64_tr_b16 v[16:17], v141 offset:12288
    ds_read_b64_tr_b16 v[18:19], v141 offset:13056
    v_mfma_f32_32x32x16_bf16 v[192:207], v[32:35], v[228:231], v[192:207]
    ds_read_b64_tr_b16 v[20:21], v141 offset:12352
    ds_read_b64_tr_b16 v[22:23], v141 offset:13120
    v_mfma_f32_32x32x16_bf16 v[208:223], v[36:39], v[228:231], v[208:223]
    ds_read_b64_tr_b16 v[24:25], v141 offset:12416
    ds_read_b64_tr_b16 v[26:27], v141 offset:13184
    s_waitcnt lgkmcnt(7)
    v_mfma_f32_32x32x16_bf16 v[176:191], v[40:43], v[232:235], v[176:191]
    ds_read_b128 v[228:231], v138 offset:16384
    ds_read_b64_tr_b16 v[28:29], v142 offset:12288
    ds_read_b64_tr_b16 v[30:31], v142 offset:13056
    v_mfma_f32_16x16x32_bf16 v[236:239], v[248:251], v[40:43], v[236:239]
    v_mfma_f32_32x32x16_bf16 v[192:207], v[44:47], v[232:235], v[192:207]
    ds_read_b64_tr_b16 v[32:33], v142 offset:12352
    ds_read_b64_tr_b16 v[34:35], v142 offset:13120
    v_mfma_f32_16x16x32_bf16 v[240:243], v[248:251], v[44:47], v[240:243]
    v_mfma_f32_32x32x16_bf16 v[208:223], v[48:51], v[232:235], v[208:223]
    ds_read_b64_tr_b16 v[36:37], v142 offset:12416
    ds_read_b64_tr_b16 v[38:39], v142 offset:13184
    v_mfma_f32_16x16x32_bf16 v[244:247], v[248:251], v[48:51], v[244:247]
    s_waitcnt lgkmcnt(7)
    v_mfma_f32_32x32x16_bf16 v[176:191], v[16:19], v[224:227], v[176:191]
    ds_read_b128 v[232:235], v139 offset:16384
    ds_read_b64_tr_b16 v[40:41], v143 offset:12288
    ds_read_b64_tr_b16 v[42:43], v143 offset:13056
    v_mfma_f32_32x32x16_bf16 v[192:207], v[20:23], v[224:227], v[192:207]
    ds_read_b64_tr_b16 v[44:45], v143 offset:12352
    ds_read_b64_tr_b16 v[46:47], v143 offset:13120
    v_mfma_f32_32x32x16_bf16 v[208:223], v[24:27], v[224:227], v[208:223]
    ds_read_b64_tr_b16 v[48:49], v143 offset:12416
    ds_read_b64_tr_b16 v[50:51], v143 offset:13184
    s_barrier
    s_waitcnt lgkmcnt(7)
    v_mfma_f32_32x32x16_bf16 v[176:191], v[28:31], v[228:231], v[176:191]
    ds_read_b128 v[224:227], v136 offset:32768
    ds_read_b64_tr_b16 v[16:17], v140 offset:24576
    ds_read_b64_tr_b16 v[18:19], v140 offset:25344
    v_mfma_f32_32x32x16_bf16 v[192:207], v[32:35], v[228:231], v[192:207]
    ds_read_b64_tr_b16 v[20:21], v140 offset:24640
    ds_read_b64_tr_b16 v[22:23], v140 offset:25408
    v_mfma_f32_32x32x16_bf16 v[208:223], v[36:39], v[228:231], v[208:223]
    ds_read_b64_tr_b16 v[24:25], v140 offset:24704
    ds_read_b64_tr_b16 v[26:27], v140 offset:25472
    s_waitcnt lgkmcnt(7)
    v_mfma_f32_32x32x16_bf16 v[176:191], v[40:43], v[232:235], v[176:191]
    ds_read_b128 v[228:231], v137 offset:32768
    ds_read_b64_tr_b16 v[28:29], v141 offset:24576
    ds_read_b64_tr_b16 v[30:31], v141 offset:25344
    v_mfma_f32_32x32x16_bf16 v[192:207], v[44:47], v[232:235], v[192:207]
    ds_read_b64_tr_b16 v[32:33], v141 offset:24640
    ds_read_b64_tr_b16 v[34:35], v141 offset:25408
    v_mfma_f32_32x32x16_bf16 v[208:223], v[48:51], v[232:235], v[208:223]
    ds_read_b64_tr_b16 v[36:37], v141 offset:24704
    ds_read_b64_tr_b16 v[38:39], v141 offset:25472
    s_waitcnt vmcnt(0)
    s_mov_b32 s66, 0
L_stat_2004:
    v_cmp_ne_u32 vcc, s61, v253
    v_cmp_ne_u32_e64 s[64:65], s61, v255
    s_nop 4
    s_or_b64 vcc, vcc, s[64:65]
    s_cbranch_scc0 L_statx_2005
    s_add_u32 s66, s66, 1
    s_cmp_gt_u32 s66, 400000
    s_cbranch_scc1 L_statx_2005
    buffer_load_dwordx4 v[252:255], v10, s[32:35], 0 offen sc1
    s_waitcnt vmcnt(0)
    s_branch L_stat_2004
L_statx_2005:
    s_waitcnt lgkmcnt(7)
    v_mfma_f32_32x32x16_bf16 v[176:191], v[16:19], v[224:227], v[176:191]
    ds_read_b128 v[232:235], v138 offset:32768
    ds_read_b64_tr_b16 v[40:41], v142 offset:24576
    ds_read_b64_tr_b16 v[42:43], v142 offset:25344
    v_mfma_f32_16x16x32_bf16 v[236:239], v[248:251], v[16:19], v[236:239]
    v_mov_b32 v11, 0xffff
    v_sub_f32 v15, 0, v252
    v_mfma_f32_32x32x16_bf16 v[192:207], v[20:23], v[224:227], v[192:207]
    ds_read_b64_tr_b16 v[44:45], v142 offset:24640
    ds_read_b64_tr_b16 v[46:47], v142 offset:25408
    v_mfma_f32_16x16x32_bf16 v[240:243], v[248:251], v[20:23], v[240:243]
    v_cvt_pk_bf16_f32 v52, v15, v15
    v_and_b32 v14, 0xffff0000, v52
    v_mfma_f32_32x32x16_bf16 v[208:223], v[24:27], v[224:227], v[208:223]
    ds_read_b64_tr_b16 v[48:49], v142 offset:24704
    ds_read_b64_tr_b16 v[50:51], v142 offset:25472
    v_mfma_f32_16x16x32_bf16 v[244:247], v[248:251], v[24:27], v[244:247]
    v_sub_f32 v14, v15, v14
    v_cvt_pk_bf16_f32 v13, v14, v14
    s_waitcnt lgkmcnt(7)
    v_mfma_f32_32x32x16_bf16 v[176:191], v[28:31], v[228:231], v[176:191]
    ds_read_b128 v[224:227], v139 offset:32768
    ds_read_b64_tr_b16 v[16:17], v143 offset:24576
    ds_read_b64_tr_b16 v[18:19], v143 offset:25344
    v_and_b32 v53, 0xffff, v13
    v_mov_b32 v54, 0
    v_mfma_f32_32x32x16_bf16 v[192:207], v[32:35], v[228:231], v[192:207]
    ds_read_b64_tr_b16 v[20:21], v143 offset:24640
    ds_read_b64_tr_b16 v[22:23], v143 offset:25408
    v_mov_b32 v55, 0
    v_cmp_gt_u32 vcc, 32, v0
    v_mfma_f32_32x32x16_bf16 v[208:223], v[36:39], v[228:231], v[208:223]
    ds_read_b64_tr_b16 v[24:25], v143 offset:24704
    ds_read_b64_tr_b16 v[26:27], v143 offset:25472
    v_cndmask_b32 v52, 0, v52, vcc
    v_cndmask_b32 v53, 0, v53, vcc
    s_barrier
    s_waitcnt lgkmcnt(7)
    v_mfma_f32_32x32x16_bf16 v[176:191], v[40:43], v[232:235], v[176:191]
    ds_read_b128 v[228:231], v136 offset:49152
    ds_read_b64_tr_b16 v[28:29], v140 offset:36864
    ds_read_b64_tr_b16 v[30:31], v140 offset:37632
    v_cndmask_b32 v54, 0, v54, vcc
    v_mfma_f32_32x32x16_bf16 v[192:207], v[44:47], v[232:235], v[192:207]
    ds_read_b64_tr_b16 v[32:33], v140 offset:36928
    ds_read_b64_tr_b16 v[34:35], v140 offset:37696
    v_mfma_f32_32x32x16_bf16 v[208:223], v[48:51], v[232:235], v[208:223]
    ds_read_b64_tr_b16 v[36:37], v140 offset:36992
    ds_read_b64_tr_b16 v[38:39], v140 offset:37760
    s_waitcnt lgkmcnt(7)
    v_mfma_f32_32x32x16_bf16 v[176:191], v[16:19], v[224:227], v[176:191]
    ds_read_b128 v[232:235], v137 offset:49152
    ds_read_b64_tr_b16 v[40:41], v141 offset:36864
    ds_read_b64_tr_b16 v[42:43], v141 offset:37632
    v_mfma_f32_32x32x16_bf16 v[192:207], v[20:23], v[224:227], v[192:207]
    ds_read_b64_tr_b16 v[44:45], v141 offset:36928
    ds_read_b64_tr_b16 v[46:47], v141 offset:37696
    v_mfma_f32_32x32x16_bf16 v[208:223], v[24:27], v[224:227], v[208:223]
    ds_read_b64_tr_b16 v[48:49], v141 offset:36992
    ds_read_b64_tr_b16 v[50:51], v141 offset:37760
    s_waitcnt lgkmcnt(7)
    v_mfma_f32_32x32x16_bf16 v[176:191], v[28:31], v[228:231], v[176:191]
    ds_read_b128 v[224:227], v138 offset:49152
    ds_read_b64_tr_b16 v[16:17], v142 offset:36864
    ds_read_b64_tr_b16 v[18:19], v142 offset:37632
    v_mfma_f32_16x16x32_bf16 v[236:239], v[248:251], v[28:31], v[236:239]
    v_mfma_f32_32x32x16_bf16 v[192:207], v[32:35], v[228:231], v[192:207]
    ds_read_b64_tr_b16 v[20:21], v142 offset:36928
    ds_read_b64_tr_b16 v[22:23], v142 offset:37696
    v_mfma_f32_16x16x32_bf16 v[240:243], v[248:251], v[32:35], v[240:243]
    v_mfma_f32_32x32x16_bf16 v[208:223], v[36:39], v[228:231], v[208:223]
    ds_read_b64_tr_b16 v[24:25], v142 offset:36992
    ds_read_b64_tr_b16 v[26:27], v142 offset:37760
    v_mfma_f32_16x16x32_bf16 v[244:247], v[248:251], v[36:39], v[244:247]
    s_waitcnt lgkmcnt(7)
    v_mfma_f32_32x32x16_bf16 v[176:191], v[40:43], v[232:235], v[176:191]
    ds_read_b128 v[228:231], v139 offset:49152
    ds_read_b64_tr_b16 v[28:29], v143 offset:36864
    ds_read_b64_tr_b16 v[30:31], v143 offset:37632
    v_mfma_f32_32x32x16_bf16 v[192:207], v[44:47], v[232:235], v[192:207]
    ds_read_b64_tr_b16 v[32:33], v143 offset:36928
    ds_read_b64_tr_b16 v[34:35], v143 offset:37696
    v_mfma_f32_32x32x16_bf16 v[208:223], v[48:51], v[232:235], v[208:223]
    ds_read_b64_tr_b16 v[36:37], v143 offset:36992
    ds_read_b64_tr_b16 v[38:39], v143 offset:37760
    s_mov_b64 exec, 0xffff
    ds_write2_b32 v8, v236, v237 offset0:0 offset1:16
    ds_write2_b32 v8, v240, v241 offset0:32 offset1:48
    ds_write2_b32 v8, v244, v245 offset0:64 offset1:80
    s_mov_b64 exec, -1
    s_waitcnt lgkmcnt(10)
    v_mfma_f32_32x32x16_bf16 v[176:191], v[16:19], v[224:227], v[176:191]
    v_mfma_f32_32x32x16_bf16 v[192:207], v[20:23], v[224:227], v[192:207]
    v_mfma_f32_32x32x16_bf16 v[208:223], v[24:27], v[224:227], v[208:223]
    s_waitcnt lgkmcnt(0)
    s_barrier
    ds_read_b32 v236, v9 offset:0
    ds_read_b32 v237, v9 offset:768
    ds_read_b32 v238, v9 offset:1536
    ds_read_b32 v239, v9 offset:2304
    ds_read_b32 v240, v9 offset:128
    ds_read_b32 v241, v9 offset:896
    ds_read_b32 v242, v9 offset:1664
    ds_read_b32 v243, v9 offset:2432
    ds_read_b32 v244, v9 offset:256
    ds_read_b32 v245, v9 offset:1024
    ds_read_b32 v246, v9 offset:1792
    ds_read_b32 v247, v9 offset:2560
    v_mfma_f32_32x32x16_bf16 v[176:191], v[28:31], v[228:231], v[176:191]
    v_mfma_f32_32x32x16_bf16 v[192:207], v[32:35], v[228:231], v[192:207]
    v_mfma_f32_32x32x16_bf16 v[208:223], v[36:39], v[228:231], v[208:223]
    v_mov_b32 v226, 0
    v_mov_b32 v227, 0
    s_waitcnt lgkmcnt(8)
    v_add_f32 v236, v236, v237
    v_add_f32 v238, v238, v239
    v_add_f32 v236, v236, v238
    v_cvt_pk_bf16_f32 v12, v236, v236
    v_and_b32 v14, 0xffff0000, v12
    v_sub_f32 v14, v236, v14
    v_cvt_pk_bf16_f32 v13, v14, v14
    v_bfi_b32 v224, v11, v12, v13
    v_and_b32 v225, 0xffff, v12
    s_nop 1
    v_mfma_f32_32x32x16_bf16 v[176:191], v[224:227], v[52:55], v[176:191]
    v_mov_b32 v230, 0
    v_mov_b32 v231, 0
    s_waitcnt lgkmcnt(4)
    v_add_f32 v240, v240, v241
    v_add_f32 v242, v242, v243
    v_add_f32 v240, v240, v242
    v_cvt_pk_bf16_f32 v12, v240, v240
    v_and_b32 v14, 0xffff0000, v12
    v_sub_f32 v14, v240, v14
    v_cvt_pk_bf16_f32 v13, v14, v14
    v_bfi_b32 v228, v11, v12, v13
    v_and_b32 v229, 0xffff, v12
    s_nop 1
    v_mfma_f32_32x32x16_bf16 v[192:207], v[228:231], v[52:55], v[192:207]
    v_mov_b32 v234, 0
    v_mov_b32 v235, 0
    s_waitcnt lgkmcnt(0)
    v_add_f32 v244, v244, v245
    v_add_f32 v246, v246, v247
    v_add_f32 v244, v244, v246
    v_cvt_pk_bf16_f32 v12, v244, v244
    v_and_b32 v14, 0xffff0000, v12
    v_sub_f32 v14, v244, v14
    v_cvt_pk_bf16_f32 v13, v14, v14
    v_bfi_b32 v232, v11, v12, v13
    v_and_b32 v233, 0xffff, v12
    s_nop 1
    v_mfma_f32_32x32x16_bf16 v[208:223], v[232:235], v[52:55], v[208:223]
    s_setprio 2
    s_lshl_b32 s63, s72, 10
    s_add_u32 s63, s63, 1048576
    s_add_u32 s64, s69, 0
    s_cmp_lt_u32 s64, 16
    s_cselect_b32 s65, 0x3eb8aa3b, 1.0
    v_mul_f32 v9, s65, v254
    s_lshl_b32 s62, s64, 17
    s_add_u32 s62, s62, s63
    v_mul_f32 v176, v176, v9
    v_mul_f32 v177, v177, v9
    v_mul_f32 v178, v178, v9
    v_mul_f32 v179, v179, v9
    v_mul_f32 v180, v180, v9
    v_mul_f32 v181, v181, v9
    v_mul_f32 v182, v182, v9
    v_mul_f32 v183, v183, v9
    v_mul_f32 v184, v184, v9
    v_mul_f32 v185, v185, v9
    v_mul_f32 v186, v186, v9
    v_mul_f32 v187, v187, v9
    v_mul_f32 v188, v188, v9
    v_mul_f32 v189, v189, v9
    v_mul_f32 v190, v190, v9
    v_mul_f32 v191, v191, v9
    v_cvt_pk_bf16_f32 v16, v176, v177
    v_cvt_pk_bf16_f32 v17, v178, v179
    v_cvt_pk_bf16_f32 v18, v180, v181
    v_cvt_pk_bf16_f32 v19, v182, v183
    v_cvt_pk_bf16_f32 v20, v184, v185
    v_cvt_pk_bf16_f32 v21, v186, v187
    v_cvt_pk_bf16_f32 v22, v188, v189
    v_cvt_pk_bf16_f32 v23, v190, v191
    s_cmp_ge_u32 s64, 32
    s_cbranch_scc1 L_vt_2006
    buffer_store_dwordx4 v[16:19], v2, s[32:35], s62 offen sc1
    s_add_u32 s62, s62, 65536
    buffer_store_dwordx4 v[20:23], v2, s[32:35], s62 offen sc1
    s_branch L_vte_2007
L_vt_2006:
    ds_write_b64 v4, v[16:17] offset:0
    ds_write_b64 v4, v[18:19] offset:16
    ds_write_b64 v4, v[20:21] offset:32
    ds_write_b64 v4, v[22:23] offset:48
    ds_read_b64_tr_b16 v[40:41], v6 offset:0
    ds_read_b64_tr_b16 v[42:43], v6 offset:576
    ds_read_b64_tr_b16 v[44:45], v6 offset:1152
    ds_read_b64_tr_b16 v[46:47], v6 offset:1728
    s_waitcnt lgkmcnt(0)
    buffer_store_dwordx4 v[40:43], v7, s[32:35], s62 offen offset:0 sc1
    buffer_store_dwordx4 v[44:47], v7, s[32:35], s62 offen offset:512 sc1
L_vte_2007:
    s_add_u32 s64, s69, 1
    s_cmp_lt_u32 s64, 16
    s_cselect_b32 s65, 0x3eb8aa3b, 1.0
    v_mul_f32 v9, s65, v254
    s_lshl_b32 s62, s64, 17
    s_add_u32 s62, s62, s63
    v_mul_f32 v192, v192, v9
    v_mul_f32 v193, v193, v9
    v_mul_f32 v194, v194, v9
    v_mul_f32 v195, v195, v9
    v_mul_f32 v196, v196, v9
    v_mul_f32 v197, v197, v9
    v_mul_f32 v198, v198, v9
    v_mul_f32 v199, v199, v9
    v_mul_f32 v200, v200, v9
    v_mul_f32 v201, v201, v9
    v_mul_f32 v202, v202, v9
    v_mul_f32 v203, v203, v9
    v_mul_f32 v204, v204, v9
    v_mul_f32 v205, v205, v9
    v_mul_f32 v206, v206, v9
    v_mul_f32 v207, v207, v9
    v_cvt_pk_bf16_f32 v24, v192, v193
    v_cvt_pk_bf16_f32 v25, v194, v195
    v_cvt_pk_bf16_f32 v26, v196, v197
    v_cvt_pk_bf16_f32 v27, v198, v199
    v_cvt_pk_bf16_f32 v28, v200, v201
    v_cvt_pk_bf16_f32 v29, v202, v203
    v_cvt_pk_bf16_f32 v30, v204, v205
    v_cvt_pk_bf16_f32 v31, v206, v207
    s_cmp_ge_u32 s64, 32
    s_cbranch_scc1 L_vt_2008
    buffer_store_dwordx4 v[24:27], v2, s[32:35], s62 offen sc1
    s_add_u32 s62, s62, 65536
    buffer_store_dwordx4 v[28:31], v2, s[32:35], s62 offen sc1
    s_branch L_vte_2009
L_vt_2008:
    ds_write_b64 v4, v[24:25] offset:0
    ds_write_b64 v4, v[26:27] offset:16
    ds_write_b64 v4, v[28:29] offset:32
    ds_write_b64 v4, v[30:31] offset:48
    ds_read_b64_tr_b16 v[48:49], v6 offset:0
    ds_read_b64_tr_b16 v[50:51], v6 offset:576
    ds_read_b64_tr_b16 v[52:53], v6 offset:1152
    ds_read_b64_tr_b16 v[54:55], v6 offset:1728
    s_waitcnt lgkmcnt(0)
    buffer_store_dwordx4 v[48:51], v7, s[32:35], s62 offen offset:0 sc1
    buffer_store_dwordx4 v[52:55], v7, s[32:35], s62 offen offset:512 sc1
L_vte_2009:
    s_add_u32 s64, s69, 2
    s_cmp_lt_u32 s64, 16
    s_cselect_b32 s65, 0x3eb8aa3b, 1.0
    v_mul_f32 v9, s65, v254
    s_lshl_b32 s62, s64, 17
    s_add_u32 s62, s62, s63
    v_mul_f32 v208, v208, v9
    v_mul_f32 v209, v209, v9
    v_mul_f32 v210, v210, v9
    v_mul_f32 v211, v211, v9
    v_mul_f32 v212, v212, v9
    v_mul_f32 v213, v213, v9
    v_mul_f32 v214, v214, v9
    v_mul_f32 v215, v215, v9
    v_mul_f32 v216, v216, v9
    v_mul_f32 v217, v217, v9
    v_mul_f32 v218, v218, v9
    v_mul_f32 v219, v219, v9
    v_mul_f32 v220, v220, v9
    v_mul_f32 v221, v221, v9
    v_mul_f32 v222, v222, v9
    v_mul_f32 v223, v223, v9
    v_cvt_pk_bf16_f32 v32, v208, v209
    v_cvt_pk_bf16_f32 v33, v210, v211
    v_cvt_pk_bf16_f32 v34, v212, v213
    v_cvt_pk_bf16_f32 v35, v214, v215
    v_cvt_pk_bf16_f32 v36, v216, v217
    v_cvt_pk_bf16_f32 v37, v218, v219
    v_cvt_pk_bf16_f32 v38, v220, v221
    v_cvt_pk_bf16_f32 v39, v222, v223
    s_cmp_ge_u32 s64, 32
    s_cbranch_scc1 L_vt_2010
    buffer_store_dwordx4 v[32:35], v2, s[32:35], s62 offen sc1
    s_add_u32 s62, s62, 65536
    buffer_store_dwordx4 v[36:39], v2, s[32:35], s62 offen sc1
    s_branch L_vte_2011
L_vt_2010:
    ds_write_b64 v4, v[32:33] offset:0
    ds_write_b64 v4, v[34:35] offset:16
    ds_write_b64 v4, v[36:37] offset:32
    ds_write_b64 v4, v[38:39] offset:48
    ds_read_b64_tr_b16 v[40:41], v6 offset:0
    ds_read_b64_tr_b16 v[42:43], v6 offset:576
    ds_read_b64_tr_b16 v[44:45], v6 offset:1152
    ds_read_b64_tr_b16 v[46:47], v6 offset:1728
    s_waitcnt lgkmcnt(0)
    buffer_store_dwordx4 v[40:43], v7, s[32:35], s62 offen offset:0 sc1
    buffer_store_dwordx4 v[44:47], v7, s[32:35], s62 offen offset:512 sc1
L_vte_2011:
    s_lshl_b32 s68, s11, 2
    s_add_u32 s68, s68, s57
    s_lshl_b32 s64, s68, 16
    s_add_u32 s65, s64, 1048576
    s_add_u32 s28, s24, s65
    s_addc_u32 s29, s25, 0
    s_mov_b32 s30, 65536
    s_mov_b32 s31, 0x20000
    s_add_u32 s65, s64, 3145728
    s_add_u32 s36, s24, s65
    s_addc_u32 s37, s25, 0
    s_mov_b32 s38, 65536
    s_mov_b32 s39, 0x20000
    s_add_u32 s65, s64, 5242880
    s_add_u32 s40, s24, s65
    s_addc_u32 s41, s25, 0
    s_mov_b32 s42, 65536
    s_mov_b32 s43, 0x20000
    s_lshl_b32 s69, s75, 10
    s_lshr_b32 s64, s10, 1
    s_lshl_b32 s72, s64, 12
    s_sub_u32 s64, s64, 2
    s_max_i32 s64, s64, 0
    s_lshl_b32 s73, s64, 12
    s_mov_b32 s74, s73
    s_and_b32 s65, s10, 1
    s_lshl_b32 s65, s65, 3
    s_add_u32 s72, s72, s65
    s_lshr_b32 s64, s68, 1
    s_add_u32 s65, s64, 0
    s_mul_i32 s65, s65, 43
    s_lshr_b32 s65, s65, 7
    s_lshl_b32 s65, s65, 8
    s_add_u32 s72, s72, s65
    s_add_u32 s65, s64, 16
    s_mul_i32 s65, s65, 43
    s_lshr_b32 s65, s65, 7
    s_lshl_b32 s65, s65, 8
    s_add_u32 s73, s73, s65
    s_add_u32 s65, s64, 32
    s_mul_i32 s65, s65, 43
    s_lshr_b32 s65, s65, 7
    s_lshl_b32 s65, s65, 8
    s_add_u32 s74, s74, s65
    v_lshrrev_b32 v3, 5, v0
    v_lshlrev_b32 v3, 8, v3
    v_and_b32 v5, 15, v0
    v_lshl_add_u32 v3, v5, 4, v3
    s_lshl_b32 s62, s58, 4
    s_add_u32 s62, s62, s59
    s_lshl_b32 s62, s62, 8
    s_lshl_b32 s64, s57, 2
    s_add_u32 s62, s62, s64
    s_add_u32 s62, s62, 524288
    s_waitcnt vmcnt(0)
    v_mov_b32 v14, s61
    v_mov_b32 v15, 0
    s_mov_b64 exec, 1
    buffer_store_dword v14, v15, s[32:35], s62 offen sc1
    s_mov_b64 exec, -1
    v_lshrrev_b32 v18, 3, v0
    v_bfe_u32 v19, v0, 4, 1
    v_lshlrev_b32 v19, 2, v19
    v_and_b32 v20, 7, v0
    v_xor_b32 v20, v20, v19
    v_lshlrev_b32 v20, 4, v20
    v_lshl_add_u32 v16, v18, 10, v20
    s_lshl_b32 s64, s77, 7
    v_add_u32 v16, s64, v16
    v_add_u32 v17, 7168, v16
    s_mul_i32 s26, s57, 360448
    s_lshl_b32 s27, s57, 11
    s_mov_b32 s44, s8
    s_mov_b32 s45, s9
    s_mov_b32 s46, 524288
    s_mov_b32 s47, 0x20000
    s_mov_b32 s48, s16
    s_mov_b32 s49, s17
    s_mov_b32 s50, 1409024
    s_mov_b32 s51, 0x20000
    s_add_u32 m0, s27, 114688
    s_lshl_b32 s63, s57, 14
    s_add_u32 s63, s63, 262144
    buffer_load_dwordx4 v16, s[44:47], s63 offen offset:0  lds
    buffer_load_dwordx4 v17, s[44:47], s63 offen offset:1024  lds
    s_add_u32 m0, s27, 122880
    s_lshl_b32 s63, s57, 14
    s_add_u32 s63, s63, 327680
    buffer_load_dwordx4 v16, s[44:47], s63 offen offset:0  lds
    buffer_load_dwordx4 v17, s[44:47], s63 offen offset:1024  lds
    s_add_u32 m0, s27, 131072
    s_lshl_b32 s63, s57, 14
    s_add_u32 s63, s63, 393216
    buffer_load_dwordx4 v16, s[44:47], s63 offen offset:0  lds
    buffer_load_dwordx4 v17, s[44:47], s63 offen offset:1024  lds
    s_add_u32 m0, s27, 139264
    s_lshl_b32 s63, s57, 14
    s_add_u32 s63, s63, 458752
    buffer_load_dwordx4 v16, s[44:47], s63 offen offset:0  lds
    buffer_load_dwordx4 v17, s[44:47], s63 offen offset:1024  lds
    v_mov_b32 v10, 150528
    s_mov_b32 s66, 0
L_spin_2012:
    ds_read_b32 v11, v10 offset:64
    s_add_u32 s66, s66, 1
    s_cmp_gt_u32 s66, 400000
    s_cbranch_scc1 L_spinx_2013
    s_waitcnt lgkmcnt(0)
    v_readfirstlane_b32 s67, v11
    s_cmp_ge_u32 s67, 4
    s_cbranch_scc1 L_spinx_2013
    s_sleep 1
    s_branch L_spin_2012
L_spinx_2013:
    s_waitcnt lgkmcnt(0)
    s_add_u32 m0, s27, 0
    s_add_u32 s63, s26, 0
    buffer_load_dwordx4 v16, s[48:51], s63 offen offset:0  lds
    buffer_load_dwordx4 v17, s[48:51], s63 offen offset:1024  lds
    s_add_u32 m0, s27, 8192
    s_add_u32 s63, s26, 16384
    buffer_load_dwordx4 v16, s[48:51], s63 offen offset:0  lds
    buffer_load_dwordx4 v17, s[48:51], s63 offen offset:1024  lds
    s_add_u32 m0, s27, 16384
    s_add_u32 s63, s26, 32768
    buffer_load_dwordx4 v16, s[48:51], s63 offen offset:0  lds
    buffer_load_dwordx4 v17, s[48:51], s63 offen offset:1024  lds
    s_add_u32 m0, s27, 24576
    s_add_u32 s63, s26, 49152
    buffer_load_dwordx4 v16, s[48:51], s63 offen offset:0  lds
    buffer_load_dwordx4 v17, s[48:51], s63 offen offset:1024  lds
    s_add_u32 m0, s27, 65536
    s_lshl_b32 s63, s57, 14
    s_add_u32 s63, s63, 0
    buffer_load_dwordx4 v16, s[44:47], s63 offen offset:0  lds
    buffer_load_dwordx4 v17, s[44:47], s63 offen offset:1024  lds
    s_add_u32 m0, s27, 73728
    s_lshl_b32 s63, s57, 14
    s_add_u32 s63, s63, 65536
    buffer_load_dwordx4 v16, s[44:47], s63 offen offset:0  lds
    buffer_load_dwordx4 v17, s[44:47], s63 offen offset:1024  lds
    s_add_u32 m0, s27, 81920
    s_lshl_b32 s63, s57, 14
    s_add_u32 s63, s63, 131072
    buffer_load_dwordx4 v16, s[44:47], s63 offen offset:0  lds
    buffer_load_dwordx4 v17, s[44:47], s63 offen offset:1024  lds
    v_mov_b32 v10, 150528
    v_mov_b32 v11, 1
    s_andn2_b32 s62, s57, 1
    s_lshl_b32 s62, s62, 2
    v_add_u32 v13, s62, v10
    s_and_b32 s62, s57, 1
    s_cbranch_scc1 L_pp_o_2014
    s_mov_b32 s66, 0
    s_mov_b32 s64, s61
    s_mov_b32 s65, s61
L_spoll_2016:
    s_load_dwordx4 s[4:7], s[24:25], s73 offset:524288 glc
    s_load_dwordx4 s[12:15], s[24:25], s73 offset:528384 glc
    s_load_dwordx4 s[16:19], s[24:25], s73 offset:532480 glc
    s_load_dwordx4 s[44:47], s[24:25], s74 offset:524288 glc
    s_load_dwordx4 s[48:51], s[24:25], s74 offset:528384 glc
    s_load_dwordx4 s[52:55], s[24:25], s74 offset:532480 glc
    s_load_dwordx2 s[26:27], s[24:25], s72 offset:524288 glc
    s_add_u32 s66, s66, 1
    s_cmp_gt_u32 s66, 400000
    s_cbranch_scc1 L_spollx_2017
    s_waitcnt lgkmcnt(0)
    s_cmp_eq_u64 s[4:5], s[64:65]
    s_cbranch_scc0 L_spollr_2018
    s_cmp_eq_u64 s[6:7], s[64:65]
    s_cbranch_scc0 L_spollr_2018
    s_cmp_eq_u64 s[12:13], s[64:65]
    s_cbranch_scc0 L_spollr_2018
    s_cmp_eq_u64 s[14:15], s[64:65]
    s_cbranch_scc0 L_spollr_2018
    s_cmp_eq_u64 s[16:17], s[64:65]
    s_cbranch_scc0 L_spollr_2018
    s_cmp_eq_u64 s[18:19], s[64:65]
    s_cbranch_scc0 L_spollr_2018
    s_cmp_eq_u64 s[44:45], s[64:65]
    s_cbranch_scc0 L_spollr_2018
    s_cmp_eq_u64 s[46:47], s[64:65]
    s_cbranch_scc0 L_spollr_2018
    s_cmp_eq_u64 s[48:49], s[64:65]
    s_cbranch_scc0 L_spollr_2018
    s_cmp_eq_u64 s[50:51], s[64:65]
    s_cbranch_scc0 L_spollr_2018
    s_cmp_eq_u64 s[52:53], s[64:65]
    s_cbranch_scc0 L_spollr_2018
    s_cmp_eq_u64 s[54:55], s[64:65]
    s_cbranch_scc0 L_spollr_2018
    s_cmp_eq_u64 s[26:27], s[64:65]
    s_cbranch_scc1 L_spollx_2017
L_spollr_2018:
    s_sleep 12
    s_branch L_spoll_2016
L_spollx_2017:
    s_waitcnt lgkmcnt(0)
    s_mov_b64 exec, 1
    ds_add_u32 v13, v11 offset:32
    s_mov_b64 exec, -1
    s_branch L_pp_e_2015
L_pp_o_2014:
    s_mov_b32 s66, 0
L_spin_2019:
    ds_read_b32 v12, v13 offset:32
    s_add_u32 s66, s66, 1
    s_cmp_gt_u32 s66, 400000
    s_cbranch_scc1 L_spinx_2020
    s_waitcnt lgkmcnt(0)
    v_readfirstlane_b32 s67, v12
    s_cmp_ge_u32 s67, 1
    s_cbranch_scc1 L_spinx_2020
    s_sleep 1
    s_branch L_spin_2019
L_spinx_2020:
    s_waitcnt lgkmcnt(0)
L_pp_e_2015:
    v_mov_b32 v14, 150528
    v_mov_b32 v15, 1
    s_setprio 2
    buffer_load_dwordx4 v[136:139], v2, s[28:31], s69 offen offset:0 sc1
    buffer_load_dwordx4 v[140:143], v2, s[28:31], s69 offen offset:1024 sc1
    s_add_u32 s62, s69, 4294959104
    buffer_load_dwordx4 v[16:19], v2, s[36:39], s62 offen sc1
    s_add_u32 s62, s69, 4294960128
    buffer_load_dwordx4 v[20:23], v2, s[36:39], s62 offen sc1
    s_mov_b32 exec_lo, 0xffff
    s_mov_b32 exec_hi, 0xffff
    s_add_u32 s62, s69, 4294959104
    buffer_load_dwordx4 v[56:59], v3, s[40:43], s62 offen offset:0 sc1
    buffer_load_dwordx4 v[60:63], v3, s[40:43], s62 offen offset:512 sc1
    s_mov_b64 exec, -1
    s_add_u32 s62, s69, 4294961152
    buffer_load_dwordx4 v[24:27], v2, s[36:39], s62 offen sc1
    s_mov_b32 exec_lo, 0xffff
    s_mov_b32 exec_hi, 0xffff
    s_add_u32 s62, s69, 4294960128
    buffer_load_dwordx4 v[64:67], v3, s[40:43], s62 offen offset:0 sc1
    buffer_load_dwordx4 v[68:71], v3, s[40:43], s62 offen offset:512 sc1
    s_mov_b64 exec, -1
    s_add_u32 s62, s69, 4294962176
    buffer_load_dwordx4 v[28:31], v2, s[36:39], s62 offen sc1
    s_mov_b32 exec_lo, 0xffff
    s_mov_b32 exec_hi, 0xffff
    s_add_u32 s62, s69, 4294961152
    buffer_load_dwordx4 v[72:75], v3, s[40:43], s62 offen offset:0 sc1
    buffer_load_dwordx4 v[76:79], v3, s[40:43], s62 offen offset:512 sc1
    s_mov_b64 exec, -1
    s_add_u32 s62, s69, 4294963200
    buffer_load_dwordx4 v[32:35], v2, s[36:39], s62 offen sc1
    s_mov_b32 exec_lo, 0xffff
    s_mov_b32 exec_hi, 0xffff
    s_add_u32 s62, s69, 4294962176
    buffer_load_dwordx4 v[80:83], v3, s[40:43], s62 offen offset:0 sc1
    buffer_load_dwordx4 v[84:87], v3, s[40:43], s62 offen offset:512 sc1
    s_mov_b64 exec, -1
    s_add_u32 s62, s69, 4294964224
    buffer_load_dwordx4 v[36:39], v2, s[36:39], s62 offen sc1
    s_mov_b32 exec_lo, 0xffff
    s_mov_b32 exec_hi, 0xffff
    s_add_u32 s62, s69, 4294963200
    buffer_load_dwordx4 v[88:91], v3, s[40:43], s62 offen offset:0 sc1
    buffer_load_dwordx4 v[92:95], v3, s[40:43], s62 offen offset:512 sc1
    s_mov_b64 exec, -1
    s_add_u32 s62, s69, 4294965248
    buffer_load_dwordx4 v[40:43], v2, s[36:39], s62 offen sc1
    s_mov_b32 exec_lo, 0xffff
    s_mov_b32 exec_hi, 0xffff
    s_add_u32 s62, s69, 4294964224
    buffer_load_dwordx4 v[96:99], v3, s[40:43], s62 offen offset:0 sc1
    buffer_load_dwordx4 v[100:103], v3, s[40:43], s62 offen offset:512 sc1
    s_mov_b64 exec, -1
    s_add_u32 s62, s69, 4294966272
    buffer_load_dwordx4 v[44:47], v2, s[36:39], s62 offen sc1
    s_mov_b32 exec_lo, 0xffff
    s_mov_b32 exec_hi, 0xffff
    s_add_u32 s62, s69, 4294965248
    buffer_load_dwordx4 v[104:107], v3, s[40:43], s62 offen offset:0 sc1
    buffer_load_dwordx4 v[108:111], v3, s[40:43], s62 offen offset:512 sc1
    s_mov_b64 exec, -1
    s_add_u32 s62, s69, 0
    buffer_load_dwordx4 v[48:51], v2, s[36:39], s62 offen sc1
    s_mov_b32 exec_lo, 0xffff
    s_mov_b32 exec_hi, 0xffff
    s_add_u32 s62, s69, 4294966272
    buffer_load_dwordx4 v[112:115], v3, s[40:43], s62 offen offset:0 sc1
    buffer_load_dwordx4 v[116:119], v3, s[40:43], s62 offen offset:512 sc1
    s_mov_b64 exec, -1
    s_add_u32 s62, s69, 1024
    buffer_load_dwordx4 v[52:55], v2, s[36:39], s62 offen sc1
    s_mov_b32 exec_lo, 0xffff
    s_mov_b32 exec_hi, 0xffff
    s_add_u32 s62, s69, 0
    buffer_load_dwordx4 v[120:123], v3, s[40:43], s62 offen offset:0 sc1
    buffer_load_dwordx4 v[124:127], v3, s[40:43], s62 offen offset:512 sc1
    s_mov_b64 exec, -1
    s_mov_b32 exec_lo, 0xffff
    s_mov_b32 exec_hi, 0xffff
    s_add_u32 s62, s69, 1024
    buffer_load_dwordx4 v[128:131], v3, s[40:43], s62 offen offset:0 sc1
    buffer_load_dwordx4 v[132:135], v3, s[40:43], s62 offen offset:512 sc1
    s_mov_b64 exec, -1
    s_waitcnt vmcnt(28)
    s_mov_b64 exec, 1
    ds_add_u32 v14, v15 offset:68
    s_mov_b64 exec, -1
    v_mfma_f32_32x32x16_bf16 v[176:191], v[16:19], v[136:139], v[160:175]
    v_mfma_f32_32x32x16_bf16 v[192:207], v[20:23], v[136:139], 0
    s_nop 10
    v_exp_f32 v176, v176
    v_exp_f32 v177, v177
    v_exp_f32 v178, v178
    v_exp_f32 v179, v179
    v_exp_f32 v180, v180
    v_exp_f32 v181, v181
    v_exp_f32 v182, v182
    v_exp_f32 v183, v183
    v_cvt_pk_bf16_f32 v208, v176, v177
    v_cvt_pk_bf16_f32 v209, v178, v179
    v_cvt_pk_bf16_f32 v210, v180, v181
    v_cvt_pk_bf16_f32 v211, v182, v183
    v_exp_f32 v184, v184
    v_exp_f32 v185, v185
    v_exp_f32 v186, v186
    v_exp_f32 v187, v187
    s_waitcnt vmcnt(26)
    v_mfma_f32_32x32x16_bf16 v[224:239], v[56:59], v[208:211], 0
    v_exp_f32 v188, v188
    v_exp_f32 v189, v189
    v_exp_f32 v190, v190
    v_exp_f32 v191, v191
    v_cvt_pk_bf16_f32 v212, v184, v185
    v_cvt_pk_bf16_f32 v213, v186, v187
    v_cvt_pk_bf16_f32 v214, v188, v189
    v_cvt_pk_bf16_f32 v215, v190, v191
    v_exp_f32 v192, v192
    v_exp_f32 v193, v193
    v_mfma_f32_32x32x16_bf16 v[224:239], v[60:63], v[212:215], v[224:239]
    v_exp_f32 v194, v194
    v_exp_f32 v195, v195
    v_exp_f32 v196, v196
    v_exp_f32 v197, v197
    v_exp_f32 v198, v198
    v_exp_f32 v199, v199
    v_cvt_pk_bf16_f32 v216, v192, v193
    s_waitcnt vmcnt(25)
    v_mfma_f32_32x32x16_bf16 v[176:191], v[24:27], v[136:139], 0
    v_cvt_pk_bf16_f32 v217, v194, v195
    v_cvt_pk_bf16_f32 v218, v196, v197
    v_cvt_pk_bf16_f32 v219, v198, v199
    v_exp_f32 v200, v200
    v_exp_f32 v201, v201
    v_exp_f32 v202, v202
    v_exp_f32 v203, v203
    s_waitcnt vmcnt(23)
    v_mfma_f32_32x32x16_bf16 v[224:239], v[64:67], v[216:219], v[224:239]
    v_exp_f32 v204, v204
    v_exp_f32 v205, v205
    v_exp_f32 v206, v206
    v_exp_f32 v207, v207
    v_cvt_pk_bf16_f32 v220, v200, v201
    v_cvt_pk_bf16_f32 v221, v202, v203
    v_cvt_pk_bf16_f32 v222, v204, v205
    v_cvt_pk_bf16_f32 v223, v206, v207
    v_exp_f32 v176, v176
    v_exp_f32 v177, v177
    v_mfma_f32_32x32x16_bf16 v[224:239], v[68:71], v[220:223], v[224:239]
    v_exp_f32 v178, v178
    v_exp_f32 v179, v179
    v_exp_f32 v180, v180
    v_exp_f32 v181, v181
    v_exp_f32 v182, v182
    v_exp_f32 v183, v183
    v_cvt_pk_bf16_f32 v208, v176, v177
    s_waitcnt vmcnt(22)
    v_mfma_f32_32x32x16_bf16 v[192:207], v[28:31], v[136:139], 0
    v_cvt_pk_bf16_f32 v209, v178, v179
    v_cvt_pk_bf16_f32 v210, v180, v181
    v_cvt_pk_bf16_f32 v211, v182, v183
    v_exp_f32 v184, v184
    v_exp_f32 v185, v185
    v_exp_f32 v186, v186
    v_exp_f32 v187, v187
    s_waitcnt vmcnt(20)
    v_mfma_f32_32x32x16_bf16 v[224:239], v[72:75], v[208:211], v[224:239]
    v_exp_f32 v188, v188
    v_exp_f32 v189, v189
    v_exp_f32 v190, v190
    v_exp_f32 v191, v191
    v_cvt_pk_bf16_f32 v212, v184, v185
    v_cvt_pk_bf16_f32 v213, v186, v187
    v_cvt_pk_bf16_f32 v214, v188, v189
    v_cvt_pk_bf16_f32 v215, v190, v191
    v_exp_f32 v192, v192
    v_exp_f32 v193, v193
    v_mfma_f32_32x32x16_bf16 v[224:239], v[76:79], v[212:215], v[224:239]
    v_exp_f32 v194, v194
    v_exp_f32 v195, v195
    v_exp_f32 v196, v196
    v_exp_f32 v197, v197
    v_exp_f32 v198, v198
    v_exp_f32 v199, v199
    v_cvt_pk_bf16_f32 v216, v192, v193
    s_waitcnt vmcnt(19)
    v_mfma_f32_32x32x16_bf16 v[176:191], v[32:35], v[136:139], 0
    v_cvt_pk_bf16_f32 v217, v194, v195
    v_cvt_pk_bf16_f32 v218, v196, v197
    v_cvt_pk_bf16_f32 v219, v198, v199
    v_exp_f32 v200, v200
    v_exp_f32 v201, v201
    v_exp_f32 v202, v202
    v_exp_f32 v203, v203
    s_waitcnt vmcnt(17)
    v_mfma_f32_32x32x16_bf16 v[224:239], v[80:83], v[216:219], v[224:239]
    v_exp_f32 v204, v204
    v_exp_f32 v205, v205
    v_exp_f32 v206, v206
    v_exp_f32 v207, v207
    v_cvt_pk_bf16_f32 v220, v200, v201
    v_cvt_pk_bf16_f32 v221, v202, v203
    v_cvt_pk_bf16_f32 v222, v204, v205
    v_cvt_pk_bf16_f32 v223, v206, v207
    v_exp_f32 v176, v176
    v_exp_f32 v177, v177
    v_mfma_f32_32x32x16_bf16 v[224:239], v[84:87], v[220:223], v[224:239]
    v_exp_f32 v178, v178
    v_exp_f32 v179, v179
    v_exp_f32 v180, v180
    v_exp_f32 v181, v181
    v_exp_f32 v182, v182
    v_exp_f32 v183, v183
    v_cvt_pk_bf16_f32 v208, v176, v177
    s_waitcnt vmcnt(16)
    v_mfma_f32_32x32x16_bf16 v[192:207], v[36:39], v[136:139], 0
    v_cvt_pk_bf16_f32 v209, v178, v179
    v_cvt_pk_bf16_f32 v210, v180, v181
    v_cvt_pk_bf16_f32 v211, v182, v183
    v_exp_f32 v184, v184
    v_exp_f32 v185, v185
    v_exp_f32 v186, v186
    v_exp_f32 v187, v187
    s_waitcnt vmcnt(14)
    v_mfma_f32_32x32x16_bf16 v[224:239], v[88:91], v[208:211], v[224:239]
    v_exp_f32 v188, v188
    v_exp_f32 v189, v189
    v_exp_f32 v190, v190
    v_exp_f32 v191, v191
    v_cvt_pk_bf16_f32 v212, v184, v185
    v_cvt_pk_bf16_f32 v213, v186, v187
    v_cvt_pk_bf16_f32 v214, v188, v189
    v_cvt_pk_bf16_f32 v215, v190, v191
    v_exp_f32 v192, v192
    v_exp_f32 v193, v193
    v_mfma_f32_32x32x16_bf16 v[224:239], v[92:95], v[212:215], v[224:239]
    v_exp_f32 v194, v194
    v_exp_f32 v195, v195
    v_exp_f32 v196, v196
    v_exp_f32 v197, v197
    v_exp_f32 v198, v198
    v_exp_f32 v199, v199
    v_cvt_pk_bf16_f32 v216, v192, v193
    s_waitcnt vmcnt(13)
    v_mfma_f32_32x32x16_bf16 v[176:191], v[40:43], v[136:139], 0
    v_cvt_pk_bf16_f32 v217, v194, v195
    v_cvt_pk_bf16_f32 v218, v196, v197
    v_cvt_pk_bf16_f32 v219, v198, v199
    v_exp_f32 v200, v200
    v_exp_f32 v201, v201
    v_exp_f32 v202, v202
    v_exp_f32 v203, v203
    s_waitcnt vmcnt(11)
    v_mfma_f32_32x32x16_bf16 v[224:239], v[96:99], v[216:219], v[224:239]
    v_exp_f32 v204, v204
    v_exp_f32 v205, v205
    v_exp_f32 v206, v206
    v_exp_f32 v207, v207
    v_cvt_pk_bf16_f32 v220, v200, v201
    v_cvt_pk_bf16_f32 v221, v202, v203
    v_cvt_pk_bf16_f32 v222, v204, v205
    v_cvt_pk_bf16_f32 v223, v206, v207
    v_exp_f32 v176, v176
    v_exp_f32 v177, v177
    v_mfma_f32_32x32x16_bf16 v[224:239], v[100:103], v[220:223], v[224:239]
    v_exp_f32 v178, v178
    v_exp_f32 v179, v179
    v_exp_f32 v180, v180
    v_exp_f32 v181, v181
    v_exp_f32 v182, v182
    v_exp_f32 v183, v183
    v_cvt_pk_bf16_f32 v208, v176, v177
    s_waitcnt vmcnt(10)
    v_mfma_f32_32x32x16_bf16 v[192:207], v[44:47], v[136:139], 0
    v_cvt_pk_bf16_f32 v209, v178, v179
    v_cvt_pk_bf16_f32 v210, v180, v181
    v_cvt_pk_bf16_f32 v211, v182, v183
    v_exp_f32 v184, v184
    v_exp_f32 v185, v185
    v_exp_f32 v186, v186
    v_exp_f32 v187, v187
    s_waitcnt vmcnt(8)
    v_mfma_f32_32x32x16_bf16 v[224:239], v[104:107], v[208:211], v[224:239]
    v_exp_f32 v188, v188
    v_exp_f32 v189, v189
    v_exp_f32 v190, v190
    v_exp_f32 v191, v191
    v_cvt_pk_bf16_f32 v212, v184, v185
    v_cvt_pk_bf16_f32 v213, v186, v187
    v_cvt_pk_bf16_f32 v214, v188, v189
    v_cvt_pk_bf16_f32 v215, v190, v191
    v_exp_f32 v192, v192
    v_exp_f32 v193, v193
    v_mfma_f32_32x32x16_bf16 v[224:239], v[108:111], v[212:215], v[224:239]
    v_exp_f32 v194, v194
    v_exp_f32 v195, v195
    v_exp_f32 v196, v196
    v_exp_f32 v197, v197
    v_exp_f32 v198, v198
    v_exp_f32 v199, v199
    v_cvt_pk_bf16_f32 v216, v192, v193
    s_waitcnt vmcnt(7)
    v_mfma_f32_32x32x16_bf16 v[176:191], v[48:51], v[136:139], v[144:159]
    v_cvt_pk_bf16_f32 v217, v194, v195
    v_cvt_pk_bf16_f32 v218, v196, v197
    v_cvt_pk_bf16_f32 v219, v198, v199
    v_exp_f32 v200, v200
    v_exp_f32 v201, v201
    v_exp_f32 v202, v202
    v_exp_f32 v203, v203
    s_waitcnt vmcnt(5)
    v_mfma_f32_32x32x16_bf16 v[224:239], v[112:115], v[216:219], v[224:239]
    v_exp_f32 v204, v204
    v_exp_f32 v205, v205
    v_exp_f32 v206, v206
    v_exp_f32 v207, v207
    v_cvt_pk_bf16_f32 v220, v200, v201
    v_cvt_pk_bf16_f32 v221, v202, v203
    v_cvt_pk_bf16_f32 v222, v204, v205
    v_cvt_pk_bf16_f32 v223, v206, v207
    v_exp_f32 v176, v176
    v_exp_f32 v177, v177
    v_mfma_f32_32x32x16_bf16 v[224:239], v[116:119], v[220:223], v[224:239]
    v_exp_f32 v178, v178
    v_exp_f32 v179, v179
    v_exp_f32 v180, v180
    v_exp_f32 v181, v181
    v_exp_f32 v182, v182
    v_exp_f32 v183, v183
    v_cvt_pk_bf16_f32 v208, v176, v177
    v_mfma_f32_32x32x16_bf16 v[192:207], v[20:23], v[140:143], v[160:175]
    v_cvt_pk_bf16_f32 v209, v178, v179
    v_cvt_pk_bf16_f32 v210, v180, v181
    v_cvt_pk_bf16_f32 v211, v182, v183
    v_exp_f32 v184, v184
    v_exp_f32 v185, v185
    v_exp_f32 v186, v186
    v_exp_f32 v187, v187
    s_waitcnt vmcnt(2)
    v_mfma_f32_32x32x16_bf16 v[224:239], v[120:123], v[208:211], v[224:239]
    v_exp_f32 v188, v188
    v_exp_f32 v189, v189
    v_exp_f32 v190, v190
    v_exp_f32 v191, v191
    v_cvt_pk_bf16_f32 v212, v184, v185
    v_cvt_pk_bf16_f32 v213, v186, v187
    v_cvt_pk_bf16_f32 v214, v188, v189
    v_cvt_pk_bf16_f32 v215, v190, v191
    v_exp_f32 v192, v192
    v_exp_f32 v193, v193
    v_mfma_f32_32x32x16_bf16 v[224:239], v[124:127], v[212:215], v[224:239]
    v_exp_f32 v194, v194
    v_exp_f32 v195, v195
    v_exp_f32 v196, v196
    v_exp_f32 v197, v197
    v_exp_f32 v198, v198
    v_exp_f32 v199, v199
    v_cvt_pk_bf16_f32 v216, v192, v193
    v_mfma_f32_32x32x16_bf16 v[176:191], v[24:27], v[140:143], 0
    v_cvt_pk_bf16_f32 v217, v194, v195
    v_cvt_pk_bf16_f32 v218, v196, v197
    v_cvt_pk_bf16_f32 v219, v198, v199
    v_exp_f32 v200, v200
    v_exp_f32 v201, v201
    v_exp_f32 v202, v202
    v_exp_f32 v203, v203
    v_mfma_f32_32x32x16_bf16 v[240:255], v[64:67], v[216:219], 0
    v_exp_f32 v204, v204
    v_exp_f32 v205, v205
    v_exp_f32 v206, v206
    v_exp_f32 v207, v207
    v_cvt_pk_bf16_f32 v220, v200, v201
    v_cvt_pk_bf16_f32 v221, v202, v203
    v_cvt_pk_bf16_f32 v222, v204, v205
    v_cvt_pk_bf16_f32 v223, v206, v207
    v_mov_b32 v10, 0
    v_mov_b32 v11, 0
    v_dot2_f32_bf16 v12, v16, v16, 0
    v_dot2_f32_bf16 v12, v17, v17, v12
    v_dot2_f32_bf16 v12, v18, v18, v12
    v_dot2_f32_bf16 v12, v19, v19, v12
    v_dot2_f32_bf16 v13, v20, v20, 0
    v_dot2_f32_bf16 v13, v21, v21, v13
    v_dot2_f32_bf16 v13, v22, v22, v13
    v_dot2_f32_bf16 v13, v23, v23, v13
    v_max_f32 v10, v10, v12
    v_dot2_f32_bf16 v12, v24, v24, 0
    v_dot2_f32_bf16 v12, v25, v25, v12
    v_dot2_f32_bf16 v12, v26, v26, v12
    v_dot2_f32_bf16 v12, v27, v27, v12
    v_max_f32 v10, v10, v13
    v_dot2_f32_bf16 v13, v28, v28, 0
    v_dot2_f32_bf16 v13, v29, v29, v13
    v_dot2_f32_bf16 v13, v30, v30, v13
    v_dot2_f32_bf16 v13, v31, v31, v13
    v_max_f32 v10, v10, v12
    v_dot2_f32_bf16 v12, v32, v32, 0
    v_dot2_f32_bf16 v12, v33, v33, v12
    v_dot2_f32_bf16 v12, v34, v34, v12
    v_dot2_f32_bf16 v12, v35, v35, v12
    v_max_f32 v10, v10, v13
    v_dot2_f32_bf16 v13, v36, v36, 0
    v_dot2_f32_bf16 v13, v37, v37, v13
    v_dot2_f32_bf16 v13, v38, v38, v13
    v_dot2_f32_bf16 v13, v39, v39, v13
    v_max_f32 v10, v10, v12
    v_dot2_f32_bf16 v12, v40, v40, 0
    v_dot2_f32_bf16 v12, v41, v41, v12
    v_dot2_f32_bf16 v12, v42, v42, v12
    v_dot2_f32_bf16 v12, v43, v43, v12
    v_max_f32 v10, v10, v13
    v_dot2_f32_bf16 v13, v44, v44, 0
    v_dot2_f32_bf16 v13, v45, v45, v13
    v_dot2_f32_bf16 v13, v46, v46, v13
    v_dot2_f32_bf16 v13, v47, v47, v13
    v_max_f32 v10, v10, v12
    v_dot2_f32_bf16 v12, v48, v48, 0
    v_dot2_f32_bf16 v12, v49, v49, v12
    v_dot2_f32_bf16 v12, v50, v50, v12
    v_dot2_f32_bf16 v12, v51, v51, v12
    v_max_f32 v10, v10, v13
    v_dot2_f32_bf16 v13, v52, v52, 0
    v_dot2_f32_bf16 v13, v53, v53, v13
    v_dot2_f32_bf16 v13, v54, v54, v13
    v_dot2_f32_bf16 v13, v55, v55, v13
    v_max_f32 v10, v10, v12
    v_dot2_f32_bf16 v12, v136, v136, 0
    v_dot2_f32_bf16 v12, v137, v137, v12
    v_dot2_f32_bf16 v12, v138, v138, v12
    v_dot2_f32_bf16 v12, v139, v139, v12
    v_max_f32 v10, v10, v13
    v_dot2_f32_bf16 v13, v140, v140, 0
    v_dot2_f32_bf16 v13, v141, v141, v13
    v_dot2_f32_bf16 v13, v142, v142, v13
    v_dot2_f32_bf16 v13, v143, v143, v13
    v_max_f32 v11, v11, v12
    s_nop 1
    v_max_f32 v11, v11, v13
    v_max_f32_dpp v10, v10, v10 quad_perm:[1,0,3,2] row_mask:0xf bank_mask:0xf
    s_nop 1
    v_max_f32_dpp v10, v10, v10 quad_perm:[2,3,0,1] row_mask:0xf bank_mask:0xf
    s_nop 1
    v_max_f32_dpp v10, v10, v10 row_half_mirror row_mask:0xf bank_mask:0xf
    s_nop 1
    v_max_f32_dpp v10, v10, v10 row_mirror row_mask:0xf bank_mask:0xf
    s_nop 1
    v_max_f32_dpp v10, v10, v10 row_bcast:15 row_mask:0xa bank_mask:0xf
    v_max_f32_dpp v11, v11, v11 quad_perm:[1,0,3,2] row_mask:0xf bank_mask:0xf
    s_nop 1
    v_max_f32_dpp v11, v11, v11 quad_perm:[2,3,0,1] row_mask:0xf bank_mask:0xf
    s_nop 1
    v_max_f32_dpp v11, v11, v11 row_half_mirror row_mask:0xf bank_mask:0xf
    s_nop 1
    v_max_f32_dpp v11, v11, v11 row_mirror row_mask:0xf bank_mask:0xf
    s_nop 1
    v_max_f32_dpp v11, v11, v11 row_bcast:15 row_mask:0xa bank_mask:0xf
    v_readlane_b32 s66, v10, 31
    v_readlane_b32 s67, v10, 63
    v_readlane_b32 s64, v11, 31
    v_readlane_b32 s65, v11, 63
    v_mov_b32 v10, s66
    v_mov_b32 v11, s64
    v_add_f32 v10, s67, v10
    v_add_f32 v11, s65, v11
    v_mul_f32 v10, v10, v11
    v_cmp_nge_f32 vcc, 0x45800000, v10
    s_nop 4
    s_cmp_lg_u64 vcc, 0
    s_cbranch_scc1 L_attn_slow
    v_rcp_f32 v8, v232
    s_nop 0
    v_mul_f32 v224, v224, v8
    v_mul_f32 v225, v225, v8
    v_mul_f32 v226, v226, v8
    v_mul_f32 v227, v227, v8
    v_mul_f32 v228, v228, v8
    v_mul_f32 v229, v229, v8
    v_mul_f32 v230, v230, v8
    v_mul_f32 v231, v231, v8
    v_cvt_pk_bf16_f32 v232, v224, v225
    v_cvt_pk_bf16_f32 v233, v226, v227
    v_cvt_pk_bf16_f32 v234, v228, v229
    v_cvt_pk_bf16_f32 v235, v230, v231
    s_add_u32 s62, s75, 0
    s_lshl_b32 s62, s62, 5
    s_add_u32 s62, s62, s68
    s_lshl_b32 s62, s62, 10
    s_add_u32 s62, s62, 7340032
    buffer_store_dwordx4 v[232:235], v2, s[32:35], s62 offen sc1
    v_exp_f32 v176, v176
    v_exp_f32 v177, v177
    v_mfma_f32_32x32x16_bf16 v[240:255], v[68:71], v[220:223], v[240:255]
    v_exp_f32 v178, v178
    v_exp_f32 v179, v179
    v_exp_f32 v180, v180
    v_exp_f32 v181, v181
    v_exp_f32 v182, v182
    v_exp_f32 v183, v183
    v_cvt_pk_bf16_f32 v208, v176, v177
    v_mfma_f32_32x32x16_bf16 v[192:207], v[28:31], v[140:143], 0
    v_cvt_pk_bf16_f32 v209, v178, v179
    v_cvt_pk_bf16_f32 v210, v180, v181
    v_cvt_pk_bf16_f32 v211, v182, v183
    v_exp_f32 v184, v184
    v_exp_f32 v185, v185
    v_exp_f32 v186, v186
    v_exp_f32 v187, v187
    v_mfma_f32_32x32x16_bf16 v[240:255], v[72:75], v[208:211], v[240:255]
    v_exp_f32 v188, v188
    v_exp_f32 v189, v189
    v_exp_f32 v190, v190
    v_exp_f32 v191, v191
    v_cvt_pk_bf16_f32 v212, v184, v185
    v_cvt_pk_bf16_f32 v213, v186, v187
    v_cvt_pk_bf16_f32 v214, v188, v189
    v_cvt_pk_bf16_f32 v215, v190, v191
    v_exp_f32 v192, v192
    v_exp_f32 v193, v193
    v_mfma_f32_32x32x16_bf16 v[240:255], v[76:79], v[212:215], v[240:255]
    v_exp_f32 v194, v194
    v_exp_f32 v195, v195
    v_exp_f32 v196, v196
    v_exp_f32 v197, v197
    v_exp_f32 v198, v198
    v_exp_f32 v199, v199
    v_cvt_pk_bf16_f32 v216, v192, v193
    v_mfma_f32_32x32x16_bf16 v[176:191], v[32:35], v[140:143], 0
    v_cvt_pk_bf16_f32 v217, v194, v195
    v_cvt_pk_bf16_f32 v218, v196, v197
    v_cvt_pk_bf16_f32 v219, v198, v199
    v_exp_f32 v200, v200
    v_exp_f32 v201, v201
    v_exp_f32 v202, v202
    v_exp_f32 v203, v203
    v_mfma_f32_32x32x16_bf16 v[240:255], v[80:83], v[216:219], v[240:255]
    v_exp_f32 v204, v204
    v_exp_f32 v205, v205
    v_exp_f32 v206, v206
    v_exp_f32 v207, v207
    v_cvt_pk_bf16_f32 v220, v200, v201
    v_cvt_pk_bf16_f32 v221, v202, v203
    v_cvt_pk_bf16_f32 v222, v204, v205
    v_cvt_pk_bf16_f32 v223, v206, v207
    v_exp_f32 v176, v176
    v_exp_f32 v177, v177
    v_mfma_f32_32x32x16_bf16 v[240:255], v[84:87], v[220:223], v[240:255]
    v_exp_f32 v178, v178
    v_exp_f32 v179, v179
    v_exp_f32 v180, v180
    v_exp_f32 v181, v181
    v_exp_f32 v182, v182
    v_exp_f32 v183, v183
    v_cvt_pk_bf16_f32 v208, v176, v177
    v_mfma_f32_32x32x16_bf16 v[192:207], v[36:39], v[140:143], 0
    v_cvt_pk_bf16_f32 v209, v178, v179
    v_cvt_pk_bf16_f32 v210, v180, v181
    v_cvt_pk_bf16_f32 v211, v182, v183
    v_exp_f32 v184, v184
    v_exp_f32 v185, v185
    v_exp_f32 v186, v186
    v_exp_f32 v187, v187
    v_mfma_f32_32x32x16_bf16 v[240:255], v[88:91], v[208:211], v[240:255]
    v_exp_f32 v188, v188
    v_exp_f32 v189, v189
    v_exp_f32 v190, v190
    v_exp_f32 v191, v191
    v_cvt_pk_bf16_f32 v212, v184, v185
    v_cvt_pk_bf16_f32 v213, v186, v187
    v_cvt_pk_bf16_f32 v214, v188, v189
    v_cvt_pk_bf16_f32 v215, v190, v191
    v_exp_f32 v192, v192
    v_exp_f32 v193, v193
    v_mfma_f32_32x32x16_bf16 v[240:255], v[92:95], v[212:215], v[240:255]
    v_exp_f32 v194, v194
    v_exp_f32 v195, v195
    v_exp_f32 v196, v196
    v_exp_f32 v197, v197
    v_exp_f32 v198, v198
    v_exp_f32 v199, v199
    v_cvt_pk_bf16_f32 v216, v192, v193
    v_mfma_f32_32x32x16_bf16 v[176:191], v[40:43], v[140:143], 0
    v_cvt_pk_bf16_f32 v217, v194, v195
    v_cvt_pk_bf16_f32 v218, v196, v197
    v_cvt_pk_bf16_f32 v219, v198, v199
    v_exp_f32 v200, v200
    v_exp_f32 v201, v201
    v_exp_f32 v202, v202
    v_exp_f32 v203, v203
    v_mfma_f32_32x32x16_bf16 v[240:255], v[96:99], v[216:219], v[240:255]
    v_exp_f32 v204, v204
    v_exp_f32 v205, v205
    v_exp_f32 v206, v206
    v_exp_f32 v207, v207
    v_cvt_pk_bf16_f32 v220, v200, v201
    v_cvt_pk_bf16_f32 v221, v202, v203
    v_cvt_pk_bf16_f32 v222, v204, v205
    v_cvt_pk_bf16_f32 v223, v206, v207
    v_exp_f32 v176, v176
    v_exp_f32 v177, v177
    v_mfma_f32_32x32x16_bf16 v[240:255], v[100:103], v[220:223], v[240:255]
    v_exp_f32 v178, v178
    v_exp_f32 v179, v179
    v_exp_f32 v180, v180
    v_exp_f32 v181, v181
    v_exp_f32 v182, v182
    v_exp_f32 v183, v183
    v_cvt_pk_bf16_f32 v208, v176, v177
    v_mfma_f32_32x32x16_bf16 v[192:207], v[44:47], v[140:143], 0
    v_cvt_pk_bf16_f32 v209, v178, v179
    v_cvt_pk_bf16_f32 v210, v180, v181
    v_cvt_pk_bf16_f32 v211, v182, v183
    v_exp_f32 v184, v184
    v_exp_f32 v185, v185
    v_exp_f32 v186, v186
    v_exp_f32 v187, v187
    v_mfma_f32_32x32x16_bf16 v[240:255], v[104:107], v[208:211], v[240:255]
    v_exp_f32 v188, v188
    v_exp_f32 v189, v189
    v_exp_f32 v190, v190
    v_exp_f32 v191, v191
    v_cvt_pk_bf16_f32 v212, v184, v185
    v_cvt_pk_bf16_f32 v213, v186, v187
    v_cvt_pk_bf16_f32 v214, v188, v189
    v_cvt_pk_bf16_f32 v215, v190, v191
    v_exp_f32 v192, v192
    v_exp_f32 v193, v193
    v_mfma_f32_32x32x16_bf16 v[240:255], v[108:111], v[212:215], v[240:255]
    v_exp_f32 v194, v194
    v_exp_f32 v195, v195
    v_exp_f32 v196, v196
    v_exp_f32 v197, v197
    v_exp_f32 v198, v198
    v_exp_f32 v199, v199
    v_cvt_pk_bf16_f32 v216, v192, v193
    v_mfma_f32_32x32x16_bf16 v[176:191], v[48:51], v[140:143], 0
    v_cvt_pk_bf16_f32 v217, v194, v195
    v_cvt_pk_bf16_f32 v218, v196, v197
    v_cvt_pk_bf16_f32 v219, v198, v199
    v_exp_f32 v200, v200
    v_exp_f32 v201, v201
    v_exp_f32 v202, v202
    v_exp_f32 v203, v203
    v_mfma_f32_32x32x16_bf16 v[240:255], v[112:115], v[216:219], v[240:255]
    v_exp_f32 v204, v204
    v_exp_f32 v205, v205
    v_exp_f32 v206, v206
    v_exp_f32 v207, v207
    v_cvt_pk_bf16_f32 v220, v200, v201
    v_cvt_pk_bf16_f32 v221, v202, v203
    v_cvt_pk_bf16_f32 v222, v204, v205
    v_cvt_pk_bf16_f32 v223, v206, v207
    v_exp_f32 v176, v176
    v_exp_f32 v177, v177
    v_mfma_f32_32x32x16_bf16 v[240:255], v[116:119], v[220:223], v[240:255]
    v_exp_f32 v178, v178
    v_exp_f32 v179, v179
    v_exp_f32 v180, v180
    v_exp_f32 v181, v181
    v_exp_f32 v182, v182
    v_exp_f32 v183, v183
    v_cvt_pk_bf16_f32 v208, v176, v177
    v_mfma_f32_32x32x16_bf16 v[192:207], v[52:55], v[140:143], v[144:159]
    v_cvt_pk_bf16_f32 v209, v178, v179
    v_cvt_pk_bf16_f32 v210, v180, v181
    v_cvt_pk_bf16_f32 v211, v182, v183
    v_exp_f32 v184, v184
    v_exp_f32 v185, v185
    v_exp_f32 v186, v186
    v_exp_f32 v187, v187
    v_mfma_f32_32x32x16_bf16 v[240:255], v[120:123], v[208:211], v[240:255]
    v_exp_f32 v188, v188
    v_exp_f32 v189, v189
    v_exp_f32 v190, v190
    v_exp_f32 v191, v191
    v_cvt_pk_bf16_f32 v212, v184, v185
    v_cvt_pk_bf16_f32 v213, v186, v187
    v_cvt_pk_bf16_f32 v214, v188, v189
    v_cvt_pk_bf16_f32 v215, v190, v191
    v_exp_f32 v192, v192
    v_exp_f32 v193, v193
    v_mfma_f32_32x32x16_bf16 v[240:255], v[124:127], v[212:215], v[240:255]
    v_exp_f32 v194, v194
    v_exp_f32 v195, v195
    v_exp_f32 v196, v196
    v_exp_f32 v197, v197
    v_exp_f32 v198, v198
    v_exp_f32 v199, v199
    v_cvt_pk_bf16_f32 v216, v192, v193
    v_cvt_pk_bf16_f32 v217, v194, v195
    v_cvt_pk_bf16_f32 v218, v196, v197
    v_cvt_pk_bf16_f32 v219, v198, v199
    v_exp_f32 v200, v200
    v_exp_f32 v201, v201
    v_exp_f32 v202, v202
    v_exp_f32 v203, v203
    s_waitcnt vmcnt(1)
    v_mfma_f32_32x32x16_bf16 v[240:255], v[128:131], v[216:219], v[240:255]
    v_exp_f32 v204, v204
    v_exp_f32 v205, v205
    v_exp_f32 v206, v206
    v_exp_f32 v207, v207
    v_cvt_pk_bf16_f32 v220, v200, v201
    v_cvt_pk_bf16_f32 v221, v202, v203
    v_cvt_pk_bf16_f32 v222, v204, v205
    v_cvt_pk_bf16_f32 v223, v206, v207
    s_nop 1
    v_mfma_f32_32x32x16_bf16 v[240:255], v[132:135], v[220:223], v[240:255]
    s_nop 11
    v_rcp_f32 v8, v248
    s_nop 0
    v_mul_f32 v240, v240, v8
    v_mul_f32 v241, v241, v8
    v_mul_f32 v242, v242, v8
    v_mul_f32 v243, v243, v8
    v_mul_f32 v244, v244, v8
    v_mul_f32 v245, v245, v8
    v_mul_f32 v246, v246, v8
    v_mul_f32 v247, v247, v8
    v_cvt_pk_bf16_f32 v248, v240, v241
    v_cvt_pk_bf16_f32 v249, v242, v243
    v_cvt_pk_bf16_f32 v250, v244, v245
    v_cvt_pk_bf16_f32 v251, v246, v247
    s_add_u32 s62, s75, 1
    s_lshl_b32 s62, s62, 5
    s_add_u32 s62, s62, s68
    s_lshl_b32 s62, s62, 10
    s_add_u32 s62, s62, 7340032
    buffer_store_dwordx4 v[248:251], v2, s[32:35], s62 offen sc1
L_attn_done:
    s_lshl_b32 s62, s10, 3
    s_add_u32 s62, s62, s11
    s_lshl_b32 s62, s62, 5
    s_add_u32 s62, s62, s57
    s_lshl_b32 s62, s62, 2
    s_add_u32 s62, s62, 655360
    s_waitcnt vmcnt(0)
    v_mov_b32 v4, s61
    v_mov_b32 v5, 0
    s_mov_b64 exec, 1
    buffer_store_dword v4, v5, s[32:35], s62 offen sc1
    s_mov_b64 exec, -1
    v_mov_b32 v6, 150528
    s_or_b32 s64, s2, s56
    s_cmp_lg_u32 s64, 0
    s_cbranch_scc1 L_noepoch_2021
    s_mov_b32 s52, s22
    s_mov_b32 s53, s23
    s_mov_b32 s54, 256
    s_mov_b32 s55, 0x20000
    v_lshlrev_b32 v7, 7, v0
    v_and_b32 v7, 128, v7
    s_mov_b32 s66, 0
L_epoch_2022:
    buffer_load_dword v8, v7, s[52:55], 0 offen sc1
    s_add_u32 s66, s66, 1
    s_cmp_gt_u32 s66, 400000
    s_cbranch_scc1 L_noepoch_2021
    s_waitcnt vmcnt(0)
    v_cmp_gt_u32 vcc, 0x80, v8
    s_nop 4
    s_cmp_lg_u64 vcc, 0
    s_cbranch_scc1 L_epoch_2022
    s_mov_b32 s64, 458752
    s_mov_b64 exec, 1
    buffer_store_dword v4, v5, s[32:35], s64 offen sc1
    s_mov_b64 exec, -1
L_noepoch_2021:
    s_lshr_b32 s70, s57, 1
    s_and_b32 s71, s57, 1
    s_add_u32 s71, s71, s78
    s_lshl_b32 s64, s77, 7
    s_lshl_b32 s65, s70, 6
    s_add_u32 s64, s64, s65
    v_lshrrev_b32 v7, 5, v0
    v_lshlrev_b32 v8, 4, v7
    v_add_u32 v8, s64, v8
    v_and_b32 v9, 31, v0
    s_lshl_b32 s65, s71, 5
    v_add_u32 v9, s65, v9
    v_lshl_add_u32 v11, v9, 10, v8
    s_lshl_b32 s72, s76, 1
    s_add_u32 s72, s72, s70
    s_lshl_b32 s72, s72, 9
    s_mul_i32 s64, s70, 49152
    s_add_u32 s64, s64, 65536
    v_lshrrev_b32 v5, 5, v0
    v_lshlrev_b32 v14, 9, v5
    v_bfe_u32 v5, v0, 2, 2
    v_lshl_add_u32 v14, v5, 7, v14
    v_bfe_u32 v5, v0, 3, 1
    v_lshl_add_u32 v14, v5, 6, v14
    v_bfe_u32 v5, v0, 4, 1
    v_lshl_add_u32 v14, v5, 5, v14
    v_and_b32 v5, 3, v0
    v_lshl_add_u32 v14, v5, 3, v14
    v_add_u32 v14, s64, v14
    v_xor_b32 v15, 64, v14
    s_lshl_b32 s64, s70, 6
    v_xor_b32 v14, s64, v14
    v_xor_b32 v15, s64, v15
    v_mov_b32 v10, 1
    s_mov_b32 s66, 0
L_spin_2023:
    ds_read_b32 v7, v6 offset:24
    s_add_u32 s66, s66, 1
    s_cmp_gt_u32 s66, 400000
    s_cbranch_scc1 L_spinx_2024
    s_waitcnt lgkmcnt(0)
    v_readfirstlane_b32 s67, v7
    s_cmp_ge_u32 s67, 4
    s_cbranch_scc1 L_spinx_2024
    s_sleep 1
    s_branch L_spin_2023
L_spinx_2024:
    s_waitcnt lgkmcnt(0)
    s_andn2_b32 s62, s57, 1
    s_lshl_b32 s62, s62, 2
    v_add_u32 v13, s62, v6
    s_and_b32 s62, s57, 1
    s_cbranch_scc1 L_pp_o_2025
    s_mov_b32 s66, 0
    s_mov_b32 s64, s61
    s_mov_b32 s65, s61
L_spoll_2027:
    s_load_dwordx4 s[4:7], s[24:25], s72 offset:655360 glc
    s_load_dwordx4 s[12:15], s[24:25], s72 offset:655488 glc
    s_load_dwordx4 s[16:19], s[24:25], s72 offset:655616 glc
    s_load_dwordx4 s[44:47], s[24:25], s72 offset:655744 glc
    s_add_u32 s66, s66, 1
    s_cmp_gt_u32 s66, 400000
    s_cbranch_scc1 L_spollx_2028
    s_waitcnt lgkmcnt(0)
    s_cmp_eq_u64 s[4:5], s[64:65]
    s_cbranch_scc0 L_spollr_2029
    s_cmp_eq_u64 s[6:7], s[64:65]
    s_cbranch_scc0 L_spollr_2029
    s_cmp_eq_u64 s[12:13], s[64:65]
    s_cbranch_scc0 L_spollr_2029
    s_cmp_eq_u64 s[14:15], s[64:65]
    s_cbranch_scc0 L_spollr_2029
    s_cmp_eq_u64 s[16:17], s[64:65]
    s_cbranch_scc0 L_spollr_2029
    s_cmp_eq_u64 s[18:19], s[64:65]
    s_cbranch_scc0 L_spollr_2029
    s_cmp_eq_u64 s[44:45], s[64:65]
    s_cbranch_scc0 L_spollr_2029
    s_cmp_eq_u64 s[46:47], s[64:65]
    s_cbranch_scc1 L_spollx_2028
L_spollr_2029:
    s_sleep 8
    s_branch L_spoll_2027
L_spollx_2028:
    s_waitcnt lgkmcnt(0)
    s_mov_b64 exec, 1
    ds_add_u32 v13, v10 offset:48
    s_mov_b64 exec, -1
    s_branch L_pp_e_2026
L_pp_o_2025:
    s_mov_b32 s66, 0
L_spin_2030:
    ds_read_b32 v12, v13 offset:48
    s_add_u32 s66, s66, 1
    s_cmp_gt_u32 s66, 400000
    s_cbranch_scc1 L_spinx_2031
    s_waitcnt lgkmcnt(0)
    v_readfirstlane_b32 s67, v12
    s_cmp_ge_u32 s67, 1
    s_cbranch_scc1 L_spinx_2031
    s_sleep 1
    s_branch L_spin_2030
L_spinx_2031:
    s_waitcnt lgkmcnt(0)
L_pp_e_2026:
    s_lshl_b32 s62, s71, 5
    s_lshl_b32 s64, s70, 4
    s_add_u32 s62, s62, s64
    s_lshl_b32 s62, s62, 10
    s_add_u32 s62, s62, 7340032
    buffer_load_dwordx4 v[16:19], v2, s[32:35], s62 offen offset:0 sc1
    buffer_load_dwordx4 v[20:23], v2, s[32:35], s62 offen offset:1024 sc1
    buffer_load_dwordx4 v[24:27], v2, s[32:35], s62 offen offset:2048 sc1
    buffer_load_dwordx4 v[28:31], v2, s[32:35], s62 offen offset:3072 sc1
    s_add_u32 s62, s62, 4096
    buffer_load_dwordx4 v[32:35], v2, s[32:35], s62 offen offset:0 sc1
    buffer_load_dwordx4 v[36:39], v2, s[32:35], s62 offen offset:1024 sc1
    buffer_load_dwordx4 v[40:43], v2, s[32:35], s62 offen offset:2048 sc1
    buffer_load_dwordx4 v[44:47], v2, s[32:35], s62 offen offset:3072 sc1
    s_add_u32 s62, s62, 4096
    buffer_load_dwordx4 v[48:51], v2, s[32:35], s62 offen offset:0 sc1
    buffer_load_dwordx4 v[52:55], v2, s[32:35], s62 offen offset:1024 sc1
    buffer_load_dwordx4 v[56:59], v2, s[32:35], s62 offen offset:2048 sc1
    buffer_load_dwordx4 v[60:63], v2, s[32:35], s62 offen offset:3072 sc1
    s_add_u32 s62, s62, 4096
    buffer_load_dwordx4 v[64:67], v2, s[32:35], s62 offen offset:0 sc1
    buffer_load_dwordx4 v[68:71], v2, s[32:35], s62 offen offset:1024 sc1
    buffer_load_dwordx4 v[72:75], v2, s[32:35], s62 offen offset:2048 sc1
    buffer_load_dwordx4 v[76:79], v2, s[32:35], s62 offen offset:3072 sc1
    s_mov_b32 s66, 0
L_spin_2032:
    ds_read_b32 v7, v6 offset:20
    s_add_u32 s66, s66, 1
    s_cmp_gt_u32 s66, 400000
    s_cbranch_scc1 L_spinx_2033
    s_waitcnt lgkmcnt(0)
    v_readfirstlane_b32 s67, v7
    s_cmp_ge_u32 s67, 4
    s_cbranch_scc1 L_spinx_2033
    s_branch L_spin_2032
L_spinx_2033:
    s_waitcnt lgkmcnt(0)
    ds_read_b64_tr_b16 v[144:145], v14 offset:0
    ds_read_b64_tr_b16 v[146:147], v14 offset:1024
    ds_read_b64_tr_b16 v[148:149], v15 offset:0
    ds_read_b64_tr_b16 v[150:151], v15 offset:1024
    ds_read_b64_tr_b16 v[152:153], v14 offset:2048
    ds_read_b64_tr_b16 v[154:155], v14 offset:3072
    ds_read_b64_tr_b16 v[156:157], v15 offset:2048
    ds_read_b64_tr_b16 v[158:159], v15 offset:3072
    ds_read_b64_tr_b16 v[160:161], v14 offset:4096
    ds_read_b64_tr_b16 v[162:163], v14 offset:5120
    ds_read_b64_tr_b16 v[164:165], v15 offset:4096
    ds_read_b64_tr_b16 v[166:167], v15 offset:5120
    s_waitcnt vmcnt(15) lgkmcnt(8)
    v_mfma_f32_32x32x16_bf16 v[96:111], v[144:147], v[16:19], 0
    ds_read_b64_tr_b16 v[168:169], v14 offset:6144
    ds_read_b64_tr_b16 v[170:171], v14 offset:7168
    v_mfma_f32_32x32x16_bf16 v[112:127], v[148:151], v[16:19], 0
    ds_read_b64_tr_b16 v[172:173], v15 offset:6144
    ds_read_b64_tr_b16 v[174:175], v15 offset:7168
    s_waitcnt vmcnt(14) lgkmcnt(8)
    v_mfma_f32_32x32x16_bf16 v[96:111], v[152:155], v[20:23], v[96:111]
    ds_read_b64_tr_b16 v[144:145], v14 offset:8192
    ds_read_b64_tr_b16 v[146:147], v14 offset:9216
    v_mfma_f32_32x32x16_bf16 v[112:127], v[156:159], v[20:23], v[112:127]
    ds_read_b64_tr_b16 v[148:149], v15 offset:8192
    ds_read_b64_tr_b16 v[150:151], v15 offset:9216
    s_waitcnt vmcnt(13) lgkmcnt(8)
    v_mfma_f32_32x32x16_bf16 v[96:111], v[160:163], v[24:27], v[96:111]
    ds_read_b64_tr_b16 v[152:153], v14 offset:10240
    ds_read_b64_tr_b16 v[154:155], v14 offset:11264
    v_mfma_f32_32x32x16_bf16 v[112:127], v[164:167], v[24:27], v[112:127]
    ds_read_b64_tr_b16 v[156:157], v15 offset:10240
    ds_read_b64_tr_b16 v[158:159], v15 offset:11264
    s_waitcnt vmcnt(12) lgkmcnt(8)
    v_mfma_f32_32x32x16_bf16 v[96:111], v[168:171], v[28:31], v[96:111]
    ds_read_b64_tr_b16 v[160:161], v14 offset:12288
    ds_read_b64_tr_b16 v[162:163], v14 offset:13312
    v_mfma_f32_32x32x16_bf16 v[112:127], v[172:175], v[28:31], v[112:127]
    ds_read_b64_tr_b16 v[164:165], v15 offset:12288
    ds_read_b64_tr_b16 v[166:167], v15 offset:13312
    s_waitcnt vmcnt(11) lgkmcnt(8)
    v_mfma_f32_32x32x16_bf16 v[96:111], v[144:147], v[32:35], v[96:111]
    ds_read_b64_tr_b16 v[168:169], v14 offset:14336
    ds_read_b64_tr_b16 v[170:171], v14 offset:15360
    v_mfma_f32_32x32x16_bf16 v[112:127], v[148:151], v[32:35], v[112:127]
    ds_read_b64_tr_b16 v[172:173], v15 offset:14336
    ds_read_b64_tr_b16 v[174:175], v15 offset:15360
    s_waitcnt vmcnt(10) lgkmcnt(8)
    v_mfma_f32_32x32x16_bf16 v[96:111], v[152:155], v[36:39], v[96:111]
    ds_read_b64_tr_b16 v[144:145], v14 offset:16384
    ds_read_b64_tr_b16 v[146:147], v14 offset:17408
    v_mfma_f32_32x32x16_bf16 v[112:127], v[156:159], v[36:39], v[112:127]
    ds_read_b64_tr_b16 v[148:149], v15 offset:16384
    ds_read_b64_tr_b16 v[150:151], v15 offset:17408
    s_waitcnt vmcnt(9) lgkmcnt(8)
    v_mfma_f32_32x32x16_bf16 v[96:111], v[160:163], v[40:43], v[96:111]
    ds_read_b64_tr_b16 v[152:153], v14 offset:18432
    ds_read_b64_tr_b16 v[154:155], v14 offset:19456
    v_mfma_f32_32x32x16_bf16 v[112:127], v[164:167], v[40:43], v[112:127]
    ds_read_b64_tr_b16 v[156:157], v15 offset:18432
    ds_read_b64_tr_b16 v[158:159], v15 offset:19456
    s_waitcnt vmcnt(8) lgkmcnt(8)
    v_mfma_f32_32x32x16_bf16 v[96:111], v[168:171], v[44:47], v[96:111]
    ds_read_b64_tr_b16 v[160:161], v14 offset:20480
    ds_read_b64_tr_b16 v[162:163], v14 offset:21504
    v_mfma_f32_32x32x16_bf16 v[112:127], v[172:175], v[44:47], v[112:127]
    ds_read_b64_tr_b16 v[164:165], v15 offset:20480
    ds_read_b64_tr_b16 v[166:167], v15 offset:21504
    s_waitcnt vmcnt(7) lgkmcnt(8)
    v_mfma_f32_32x32x16_bf16 v[96:111], v[144:147], v[48:51], v[96:111]
    ds_read_b64_tr_b16 v[168:169], v14 offset:22528
    ds_read_b64_tr_b16 v[170:171], v14 offset:23552
    v_mfma_f32_32x32x16_bf16 v[112:127], v[148:151], v[48:51], v[112:127]
    ds_read_b64_tr_b16 v[172:173], v15 offset:22528
    ds_read_b64_tr_b16 v[174:175], v15 offset:23552
    s_waitcnt vmcnt(6) lgkmcnt(8)
    v_mfma_f32_32x32x16_bf16 v[96:111], v[152:155], v[52:55], v[96:111]
    ds_read_b64_tr_b16 v[144:145], v14 offset:24576
    ds_read_b64_tr_b16 v[146:147], v14 offset:25600
    v_mfma_f32_32x32x16_bf16 v[112:127], v[156:159], v[52:55], v[112:127]
    ds_read_b64_tr_b16 v[148:149], v15 offset:24576
    ds_read_b64_tr_b16 v[150:151], v15 offset:25600
    s_waitcnt vmcnt(5) lgkmcnt(8)
    v_mfma_f32_32x32x16_bf16 v[96:111], v[160:163], v[56:59], v[96:111]
    ds_read_b64_tr_b16 v[152:153], v14 offset:26624
    ds_read_b64_tr_b16 v[154:155], v14 offset:27648
    v_mfma_f32_32x32x16_bf16 v[112:127], v[164:167], v[56:59], v[112:127]
    ds_read_b64_tr_b16 v[156:157], v15 offset:26624
    ds_read_b64_tr_b16 v[158:159], v15 offset:27648
    s_waitcnt vmcnt(4) lgkmcnt(8)
    v_mfma_f32_32x32x16_bf16 v[96:111], v[168:171], v[60:63], v[96:111]
    ds_read_b64_tr_b16 v[160:161], v14 offset:28672
    ds_read_b64_tr_b16 v[162:163], v14 offset:29696
    v_mfma_f32_32x32x16_bf16 v[112:127], v[172:175], v[60:63], v[112:127]
    ds_read_b64_tr_b16 v[164:165], v15 offset:28672
    ds_read_b64_tr_b16 v[166:167], v15 offset:29696
    s_waitcnt vmcnt(3) lgkmcnt(8)
    v_mfma_f32_32x32x16_bf16 v[96:111], v[144:147], v[64:67], v[96:111]
    ds_read_b64_tr_b16 v[168:169], v14 offset:30720
    ds_read_b64_tr_b16 v[170:171], v14 offset:31744
    v_mfma_f32_32x32x16_bf16 v[112:127], v[148:151], v[64:67], v[112:127]
    ds_read_b64_tr_b16 v[172:173], v15 offset:30720
    ds_read_b64_tr_b16 v[174:175], v15 offset:31744
    s_waitcnt vmcnt(2) lgkmcnt(8)
    v_mfma_f32_32x32x16_bf16 v[96:111], v[152:155], v[68:71], v[96:111]
    v_mfma_f32_32x32x16_bf16 v[112:127], v[156:159], v[68:71], v[112:127]
    s_waitcnt vmcnt(1) lgkmcnt(4)
    v_mfma_f32_32x32x16_bf16 v[96:111], v[160:163], v[72:75], v[96:111]
    v_mfma_f32_32x32x16_bf16 v[112:127], v[164:167], v[72:75], v[112:127]
    s_waitcnt vmcnt(0) lgkmcnt(0)
    v_mfma_f32_32x32x16_bf16 v[96:111], v[168:171], v[76:79], v[96:111]
    v_mfma_f32_32x32x16_bf16 v[112:127], v[172:175], v[76:79], v[112:127]
    s_lshl_b32 s64, s57, 12
    s_add_u32 s64, s64, 98304
    v_add_u32 v12, s64, v2
    v_xor_b32 v13, 0x2000, v12
    s_nop 7
    ds_write_b128 v12, v[112:115] offset:0
    ds_write_b128 v12, v[116:119] offset:1024
    ds_write_b128 v12, v[120:123] offset:2048
    ds_write_b128 v12, v[124:127] offset:3072
    s_and_b32 s64, s57, 1
    s_lshl_b32 s64, s64, 1
    s_add_u32 s64, s64, s70
    s_lshl_b32 s64, s64, 12
    v_add_u32 v12, s64, v2
    s_mov_b32 s28, s20
    s_mov_b32 s29, s21
    s_mov_b32 s30, 2097152
    s_mov_b32 s31, 0x20000
    s_waitcnt lgkmcnt(0)
    s_barrier
    ds_read_b128 v[16:19], v12 offset:0
    ds_read_b128 v[20:23], v12 offset:1024
    ds_read_b128 v[24:27], v12 offset:2048
    ds_read_b128 v[28:31], v12 offset:3072
    ds_read_b128 v[32:35], v12 offset:16384
    ds_read_b128 v[36:39], v12 offset:17408
    ds_read_b128 v[40:43], v12 offset:18432
    ds_read_b128 v[44:47], v12 offset:19456
    ds_read_b128 v[48:51], v12 offset:32768
    ds_read_b128 v[52:55], v12 offset:33792
    ds_read_b128 v[56:59], v12 offset:34816
    ds_read_b128 v[60:63], v12 offset:35840
    ds_read_b128 v[64:67], v12 offset:49152
    ds_read_b128 v[68:71], v12 offset:50176
    ds_read_b128 v[72:75], v12 offset:51200
    ds_read_b128 v[76:79], v12 offset:52224
    ds_read_b128 v[80:83], v13 offset:0
    ds_read_b128 v[84:87], v13 offset:1024
    ds_read_b128 v[88:91], v13 offset:2048
    ds_read_b128 v[92:95], v13 offset:3072
    s_waitcnt lgkmcnt(15)
    v_pk_add_f32 v[96:97], v[96:97], v[16:17]
    v_pk_add_f32 v[98:99], v[98:99], v[18:19]
    v_pk_add_f32 v[100:101], v[100:101], v[20:21]
    v_pk_add_f32 v[102:103], v[102:103], v[22:23]
    v_pk_add_f32 v[104:105], v[104:105], v[24:25]
    v_pk_add_f32 v[106:107], v[106:107], v[26:27]
    v_pk_add_f32 v[108:109], v[108:109], v[28:29]
    v_pk_add_f32 v[110:111], v[110:111], v[30:31]
    s_waitcnt lgkmcnt(12)
    v_pk_add_f32 v[96:97], v[96:97], v[32:33]
    v_pk_add_f32 v[98:99], v[98:99], v[34:35]
    v_pk_add_f32 v[100:101], v[100:101], v[36:37]
    v_pk_add_f32 v[102:103], v[102:103], v[38:39]
    v_pk_add_f32 v[104:105], v[104:105], v[40:41]
    v_pk_add_f32 v[106:107], v[106:107], v[42:43]
    v_pk_add_f32 v[108:109], v[108:109], v[44:45]
    v_pk_add_f32 v[110:111], v[110:111], v[46:47]
    s_waitcnt lgkmcnt(8)
    v_pk_add_f32 v[96:97], v[96:97], v[48:49]
    v_pk_add_f32 v[98:99], v[98:99], v[50:51]
    v_pk_add_f32 v[100:101], v[100:101], v[52:53]
    v_pk_add_f32 v[102:103], v[102:103], v[54:55]
    v_pk_add_f32 v[104:105], v[104:105], v[56:57]
    v_pk_add_f32 v[106:107], v[106:107], v[58:59]
    v_pk_add_f32 v[108:109], v[108:109], v[60:61]
    v_pk_add_f32 v[110:111], v[110:111], v[62:63]
    s_waitcnt lgkmcnt(4)
    v_pk_add_f32 v[96:97], v[96:97], v[64:65]
    v_pk_add_f32 v[98:99], v[98:99], v[66:67]
    v_pk_add_f32 v[100:101], v[100:101], v[68:69]
    v_pk_add_f32 v[102:103], v[102:103], v[70:71]
    v_pk_add_f32 v[104:105], v[104:105], v[72:73]
    v_pk_add_f32 v[106:107], v[106:107], v[74:75]
    v_pk_add_f32 v[108:109], v[108:109], v[76:77]
    v_pk_add_f32 v[110:111], v[110:111], v[78:79]
    s_waitcnt lgkmcnt(0)
    v_pk_add_f32 v[96:97], v[96:97], v[80:81]
    v_pk_add_f32 v[98:99], v[98:99], v[82:83]
    v_pk_add_f32 v[100:101], v[100:101], v[84:85]
    v_pk_add_f32 v[102:103], v[102:103], v[86:87]
    v_pk_add_f32 v[104:105], v[104:105], v[88:89]
    v_pk_add_f32 v[106:107], v[106:107], v[90:91]
    v_pk_add_f32 v[108:109], v[108:109], v[92:93]
    v_pk_add_f32 v[110:111], v[110:111], v[94:95]
    v_cvt_pk_bf16_f32 v128, v96, v97
    v_cvt_pk_bf16_f32 v129, v98, v99
    v_cvt_pk_bf16_f32 v130, v100, v101
    v_cvt_pk_bf16_f32 v131, v102, v103
    v_cvt_pk_bf16_f32 v132, v104, v105
    v_cvt_pk_bf16_f32 v133, v106, v107
    v_cvt_pk_bf16_f32 v134, v108, v109
    v_cvt_pk_bf16_f32 v135, v110, v111
    v_permlane32_swap_b32 v128, v130
    v_permlane32_swap_b32 v129, v131
    buffer_store_dwordx4 v[128:131], v11, s[28:31], 0 offen offset:0
    v_permlane32_swap_b32 v132, v134
    v_permlane32_swap_b32 v133, v135
    buffer_store_dwordx4 v[132:135], v11, s[28:31], 0 offen offset:32
    s_endpgm
L_attn_slow:
    s_waitcnt vmcnt(0)
    s_nop 15
    v_mov_b32 v10, 0xff800000
    s_add_i32 s64, s75, -8
    s_cmp_lt_i32 s64, 0
    s_cbranch_scc1 L_skip_5001
    v_mfma_f32_32x32x16_bf16 v[176:191], v[16:19], v[136:139], v[160:175]
    s_nop 11
    v_max3_f32 v10, v10, v176, v177
    v_max3_f32 v10, v10, v178, v179
    v_max3_f32 v10, v10, v180, v181
    v_max3_f32 v10, v10, v182, v183
    v_max3_f32 v10, v10, v184, v185
    v_max3_f32 v10, v10, v186, v187
    v_max3_f32 v10, v10, v188, v189
    v_max3_f32 v10, v10, v190, v191
L_skip_5001:
    s_nop 7
    s_nop 7
    s_add_i32 s64, s75, -7
    s_cmp_lt_i32 s64, 0
    s_cbranch_scc1 L_skip_5002
    v_mfma_f32_32x32x16_bf16 v[192:207], v[20:23], v[136:139], 0
    s_nop 11
    v_max3_f32 v10, v10, v192, v193
    v_max3_f32 v10, v10, v194, v195
    v_max3_f32 v10, v10, v196, v197
    v_max3_f32 v10, v10, v198, v199
    v_max3_f32 v10, v10, v200, v201
    v_max3_f32 v10, v10, v202, v203
    v_max3_f32 v10, v10, v204, v205
    v_max3_f32 v10, v10, v206, v207
L_skip_5002:
    s_nop 7
    s_nop 7
    s_add_i32 s64, s75, -6
    s_cmp_lt_i32 s64, 0
    s_cbranch_scc1 L_skip_5003
    v_mfma_f32_32x32x16_bf16 v[176:191], v[24:27], v[136:139], 0
    s_nop 11
    v_max3_f32 v10, v10, v176, v177
    v_max3_f32 v10, v10, v178, v179
    v_max3_f32 v10, v10, v180, v181
    v_max3_f32 v10, v10, v182, v183
    v_max3_f32 v10, v10, v184, v185
    v_max3_f32 v10, v10, v186, v187
    v_max3_f32 v10, v10, v188, v189
    v_max3_f32 v10, v10, v190, v191
L_skip_5003:
    s_nop 7
    s_nop 7
    s_add_i32 s64, s75, -5
    s_cmp_lt_i32 s64, 0
    s_cbranch_scc1 L_skip_5004
    v_mfma_f32_32x32x16_bf16 v[192:207], v[28:31], v[136:139], 0
    s_nop 11
    v_max3_f32 v10, v10, v192, v193
    v_max3_f32 v10, v10, v194, v195
    v_max3_f32 v10, v10, v196, v197
    v_max3_f32 v10, v10, v198, v199
    v_max3_f32 v10, v10, v200, v201
    v_max3_f32 v10, v10, v202, v203
    v_max3_f32 v10, v10, v204, v205
    v_max3_f32 v10, v10, v206, v207
L_skip_5004:
    s_nop 7
    s_nop 7
    s_add_i32 s64, s75, -4
    s_cmp_lt_i32 s64, 0
    s_cbranch_scc1 L_skip_5005
    v_mfma_f32_32x32x16_bf16 v[176:191], v[32:35], v[136:139], 0
    s_nop 11
    v_max3_f32 v10, v10, v176, v177
    v_max3_f32 v10, v10, v178, v179
    v_max3_f32 v10, v10, v180, v181
    v_max3_f32 v10, v10, v182, v183
    v_max3_f32 v10, v10, v184, v185
    v_max3_f32 v10, v10, v186, v187
    v_max3_f32 v10, v10, v188, v189
    v_max3_f32 v10, v10, v190, v191
L_skip_5005:
    s_nop 7
    s_nop 7
    s_add_i32 s64, s75, -3
    s_cmp_lt_i32 s64, 0
    s_cbranch_scc1 L_skip_5006
    v_mfma_f32_32x32x16_bf16 v[192:207], v[36:39], v[136:139], 0
    s_nop 11
    v_max3_f32 v10, v10, v192, v193
    v_max3_f32 v10, v10, v194, v195
    v_max3_f32 v10, v10, v196, v197
    v_max3_f32 v10, v10, v198, v199
    v_max3_f32 v10, v10, v200, v201
    v_max3_f32 v10, v10, v202, v203
    v_max3_f32 v10, v10, v204, v205
    v_max3_f32 v10, v10, v206, v207
L_skip_5006:
    s_nop 7
    s_nop 7
    s_add_i32 s64, s75, -2
    s_cmp_lt_i32 s64, 0
    s_cbranch_scc1 L_skip_5007
    v_mfma_f32_32x32x16_bf16 v[176:191], v[40:43], v[136:139], 0
    s_nop 11
    v_max3_f32 v10, v10, v176, v177
    v_max3_f32 v10, v10, v178, v179
    v_max3_f32 v10, v10, v180, v181
    v_max3_f32 v10, v10, v182, v183
    v_max3_f32 v10, v10, v184, v185
    v_max3_f32 v10, v10, v186, v187
    v_max3_f32 v10, v10, v188, v189
    v_max3_f32 v10, v10, v190, v191
L_skip_5007:
    s_nop 7
    s_nop 7
    s_add_i32 s64, s75, -1
    s_cmp_lt_i32 s64, 0
    s_cbranch_scc1 L_skip_5008
    v_mfma_f32_32x32x16_bf16 v[192:207], v[44:47], v[136:139], 0
    s_nop 11
    v_max3_f32 v10, v10, v192, v193
    v_max3_f32 v10, v10, v194, v195
    v_max3_f32 v10, v10, v196, v197
    v_max3_f32 v10, v10, v198, v199
    v_max3_f32 v10, v10, v200, v201
    v_max3_f32 v10, v10, v202, v203
    v_max3_f32 v10, v10, v204, v205
    v_max3_f32 v10, v10, v206, v207
L_skip_5008:
    s_nop 7
    s_nop 7
    s_add_i32 s64, s75, 0
    s_cmp_lt_i32 s64, 0
    s_cbranch_scc1 L_skip_5009
    v_mfma_f32_32x32x16_bf16 v[176:191], v[48:51], v[136:139], v[144:159]
    s_nop 11
    v_max3_f32 v10, v10, v176, v177
    v_max3_f32 v10, v10, v178, v179
    v_max3_f32 v10, v10, v180, v181
    v_max3_f32 v10, v10, v182, v183
    v_max3_f32 v10, v10, v184, v185
    v_max3_f32 v10, v10, v186, v187
    v_max3_f32 v10, v10, v188, v189
    v_max3_f32 v10, v10, v190, v191
L_skip_5009:
    s_nop 7
    s_nop 7
    v_mov_b32 v11, v10
    s_nop 1
    v_permlane32_swap_b32 v10, v11
    v_max_f32 v10, v10, v11
    v_mfma_f32_32x32x16_bf16 v[176:191], v[16:19], v[136:139], v[160:175]
    s_nop 11
    v_sub_f32 v176, v176, v10
    v_min_f32 v176, 0, v176
    v_exp_f32 v176, v176
    v_sub_f32 v177, v177, v10
    v_min_f32 v177, 0, v177
    v_exp_f32 v177, v177
    v_sub_f32 v178, v178, v10
    v_min_f32 v178, 0, v178
    v_exp_f32 v178, v178
    v_sub_f32 v179, v179, v10
    v_min_f32 v179, 0, v179
    v_exp_f32 v179, v179
    v_sub_f32 v180, v180, v10
    v_min_f32 v180, 0, v180
    v_exp_f32 v180, v180
    v_sub_f32 v181, v181, v10
    v_min_f32 v181, 0, v181
    v_exp_f32 v181, v181
    v_sub_f32 v182, v182, v10
    v_min_f32 v182, 0, v182
    v_exp_f32 v182, v182
    v_sub_f32 v183, v183, v10
    v_min_f32 v183, 0, v183
    v_exp_f32 v183, v183
    v_sub_f32 v184, v184, v10
    v_min_f32 v184, 0, v184
    v_exp_f32 v184, v184
    v_sub_f32 v185, v185, v10
    v_min_f32 v185, 0, v185
    v_exp_f32 v185, v185
    v_sub_f32 v186, v186, v10
    v_min_f32 v186, 0, v186
    v_exp_f32 v186, v186
    v_sub_f32 v187, v187, v10
    v_min_f32 v187, 0, v187
    v_exp_f32 v187, v187
    v_sub_f32 v188, v188, v10
    v_min_f32 v188, 0, v188
    v_exp_f32 v188, v188
    v_sub_f32 v189, v189, v10
    v_min_f32 v189, 0, v189
    v_exp_f32 v189, v189
    v_sub_f32 v190, v190, v10
    v_min_f32 v190, 0, v190
    v_exp_f32 v190, v190
    v_sub_f32 v191, v191, v10
    v_min_f32 v191, 0, v191
    v_exp_f32 v191, v191
    v_cvt_pk_bf16_f32 v208, v176, v177
    v_cvt_pk_bf16_f32 v209, v178, v179
    v_cvt_pk_bf16_f32 v210, v180, v181
    v_cvt_pk_bf16_f32 v211, v182, v183
    v_cvt_pk_bf16_f32 v212, v184, v185
    v_cvt_pk_bf16_f32 v213, v186, v187
    v_cvt_pk_bf16_f32 v214, v188, v189
    v_cvt_pk_bf16_f32 v215, v190, v191
    v_mfma_f32_32x32x16_bf16 v[224:239], v[56:59], v[208:211], 0
    s_nop 0
    v_mfma_f32_32x32x16_bf16 v[224:239], v[60:63], v[212:215], v[224:239]
    v_mfma_f32_32x32x16_bf16 v[192:207], v[20:23], v[136:139], 0
    s_nop 11
    v_sub_f32 v192, v192, v10
    v_min_f32 v192, 0, v192
    v_exp_f32 v192, v192
    v_sub_f32 v193, v193, v10
    v_min_f32 v193, 0, v193
    v_exp_f32 v193, v193
    v_sub_f32 v194, v194, v10
    v_min_f32 v194, 0, v194
    v_exp_f32 v194, v194
    v_sub_f32 v195, v195, v10
    v_min_f32 v195, 0, v195
    v_exp_f32 v195, v195
    v_sub_f32 v196, v196, v10
    v_min_f32 v196, 0, v196
    v_exp_f32 v196, v196
    v_sub_f32 v197, v197, v10
    v_min_f32 v197, 0, v197
    v_exp_f32 v197, v197
    v_sub_f32 v198, v198, v10
    v_min_f32 v198, 0, v198
    v_exp_f32 v198, v198
    v_sub_f32 v199, v199, v10
    v_min_f32 v199, 0, v199
    v_exp_f32 v199, v199
    v_sub_f32 v200, v200, v10
    v_min_f32 v200, 0, v200
    v_exp_f32 v200, v200
    v_sub_f32 v201, v201, v10
    v_min_f32 v201, 0, v201
    v_exp_f32 v201, v201
    v_sub_f32 v202, v202, v10
    v_min_f32 v202, 0, v202
    v_exp_f32 v202, v202
    v_sub_f32 v203, v203, v10
    v_min_f32 v203, 0, v203
    v_exp_f32 v203, v203
    v_sub_f32 v204, v204, v10
    v_min_f32 v204, 0, v204
    v_exp_f32 v204, v204
    v_sub_f32 v205, v205, v10
    v_min_f32 v205, 0, v205
    v_exp_f32 v205, v205
    v_sub_f32 v206, v206, v10
    v_min_f32 v206, 0, v206
    v_exp_f32 v206, v206
    v_sub_f32 v207, v207, v10
    v_min_f32 v207, 0, v207
    v_exp_f32 v207, v207
    v_cvt_pk_bf16_f32 v216, v192, v193
    v_cvt_pk_bf16_f32 v217, v194, v195
    v_cvt_pk_bf16_f32 v218, v196, v197
    v_cvt_pk_bf16_f32 v219, v198, v199
    v_cvt_pk_bf16_f32 v220, v200, v201
    v_cvt_pk_bf16_f32 v221, v202, v203
    v_cvt_pk_bf16_f32 v222, v204, v205
    v_cvt_pk_bf16_f32 v223, v206, v207
    v_mfma_f32_32x32x16_bf16 v[224:239], v[64:67], v[216:219], v[224:239]
    s_nop 0
    v_mfma_f32_32x32x16_bf16 v[224:239], v[68:71], v[220:223], v[224:239]
    v_mfma_f32_32x32x16_bf16 v[176:191], v[24:27], v[136:139], 0
    s_nop 11
    v_sub_f32 v176, v176, v10
    v_min_f32 v176, 0, v176
    v_exp_f32 v176, v176
    v_sub_f32 v177, v177, v10
    v_min_f32 v177, 0, v177
    v_exp_f32 v177, v177
    v_sub_f32 v178, v178, v10
    v_min_f32 v178, 0, v178
    v_exp_f32 v178, v178
    v_sub_f32 v179, v179, v10
    v_min_f32 v179, 0, v179
    v_exp_f32 v179, v179
    v_sub_f32 v180, v180, v10
    v_min_f32 v180, 0, v180
    v_exp_f32 v180, v180
    v_sub_f32 v181, v181, v10
    v_min_f32 v181, 0, v181
    v_exp_f32 v181, v181
    v_sub_f32 v182, v182, v10
    v_min_f32 v182, 0, v182
    v_exp_f32 v182, v182
    v_sub_f32 v183, v183, v10
    v_min_f32 v183, 0, v183
    v_exp_f32 v183, v183
    v_sub_f32 v184, v184, v10
    v_min_f32 v184, 0, v184
    v_exp_f32 v184, v184
    v_sub_f32 v185, v185, v10
    v_min_f32 v185, 0, v185
    v_exp_f32 v185, v185
    v_sub_f32 v186, v186, v10
    v_min_f32 v186, 0, v186
    v_exp_f32 v186, v186
    v_sub_f32 v187, v187, v10
    v_min_f32 v187, 0, v187
    v_exp_f32 v187, v187
    v_sub_f32 v188, v188, v10
    v_min_f32 v188, 0, v188
    v_exp_f32 v188, v188
    v_sub_f32 v189, v189, v10
    v_min_f32 v189, 0, v189
    v_exp_f32 v189, v189
    v_sub_f32 v190, v190, v10
    v_min_f32 v190, 0, v190
    v_exp_f32 v190, v190
    v_sub_f32 v191, v191, v10
    v_min_f32 v191, 0, v191
    v_exp_f32 v191, v191
    v_cvt_pk_bf16_f32 v208, v176, v177
    v_cvt_pk_bf16_f32 v209, v178, v179
    v_cvt_pk_bf16_f32 v210, v180, v181
    v_cvt_pk_bf16_f32 v211, v182, v183
    v_cvt_pk_bf16_f32 v212, v184, v185
    v_cvt_pk_bf16_f32 v213, v186, v187
    v_cvt_pk_bf16_f32 v214, v188, v189
    v_cvt_pk_bf16_f32 v215, v190, v191
    v_mfma_f32_32x32x16_bf16 v[224:239], v[72:75], v[208:211], v[224:239]
    s_nop 0
    v_mfma_f32_32x32x16_bf16 v[224:239], v[76:79], v[212:215], v[224:239]
    v_mfma_f32_32x32x16_bf16 v[192:207], v[28:31], v[136:139], 0
    s_nop 11
    v_sub_f32 v192, v192, v10
    v_min_f32 v192, 0, v192
    v_exp_f32 v192, v192
    v_sub_f32 v193, v193, v10
    v_min_f32 v193, 0, v193
    v_exp_f32 v193, v193
    v_sub_f32 v194, v194, v10
    v_min_f32 v194, 0, v194
    v_exp_f32 v194, v194
    v_sub_f32 v195, v195, v10
    v_min_f32 v195, 0, v195
    v_exp_f32 v195, v195
    v_sub_f32 v196, v196, v10
    v_min_f32 v196, 0, v196
    v_exp_f32 v196, v196
    v_sub_f32 v197, v197, v10
    v_min_f32 v197, 0, v197
    v_exp_f32 v197, v197
    v_sub_f32 v198, v198, v10
    v_min_f32 v198, 0, v198
    v_exp_f32 v198, v198
    v_sub_f32 v199, v199, v10
    v_min_f32 v199, 0, v199
    v_exp_f32 v199, v199
    v_sub_f32 v200, v200, v10
    v_min_f32 v200, 0, v200
    v_exp_f32 v200, v200
    v_sub_f32 v201, v201, v10
    v_min_f32 v201, 0, v201
    v_exp_f32 v201, v201
    v_sub_f32 v202, v202, v10
    v_min_f32 v202, 0, v202
    v_exp_f32 v202, v202
    v_sub_f32 v203, v203, v10
    v_min_f32 v203, 0, v203
    v_exp_f32 v203, v203
    v_sub_f32 v204, v204, v10
    v_min_f32 v204, 0, v204
    v_exp_f32 v204, v204
    v_sub_f32 v205, v205, v10
    v_min_f32 v205, 0, v205
    v_exp_f32 v205, v205
    v_sub_f32 v206, v206, v10
    v_min_f32 v206, 0, v206
    v_exp_f32 v206, v206
    v_sub_f32 v207, v207, v10
    v_min_f32 v207, 0, v207
    v_exp_f32 v207, v207
    v_cvt_pk_bf16_f32 v216, v192, v193
    v_cvt_pk_bf16_f32 v217, v194, v195
    v_cvt_pk_bf16_f32 v218, v196, v197
    v_cvt_pk_bf16_f32 v219, v198, v199
    v_cvt_pk_bf16_f32 v220, v200, v201
    v_cvt_pk_bf16_f32 v221, v202, v203
    v_cvt_pk_bf16_f32 v222, v204, v205
    v_cvt_pk_bf16_f32 v223, v206, v207
    v_mfma_f32_32x32x16_bf16 v[224:239], v[80:83], v[216:219], v[224:239]
    s_nop 0
    v_mfma_f32_32x32x16_bf16 v[224:239], v[84:87], v[220:223], v[224:239]
    v_mfma_f32_32x32x16_bf16 v[176:191], v[32:35], v[136:139], 0
    s_nop 11
    v_sub_f32 v176, v176, v10
    v_min_f32 v176, 0, v176
    v_exp_f32 v176, v176
    v_sub_f32 v177, v177, v10
    v_min_f32 v177, 0, v177
    v_exp_f32 v177, v177
    v_sub_f32 v178, v178, v10
    v_min_f32 v178, 0, v178
    v_exp_f32 v178, v178
    v_sub_f32 v179, v179, v10
    v_min_f32 v179, 0, v179
    v_exp_f32 v179, v179
    v_sub_f32 v180, v180, v10
    v_min_f32 v180, 0, v180
    v_exp_f32 v180, v180
    v_sub_f32 v181, v181, v10
    v_min_f32 v181, 0, v181
    v_exp_f32 v181, v181
    v_sub_f32 v182, v182, v10
    v_min_f32 v182, 0, v182
    v_exp_f32 v182, v182
    v_sub_f32 v183, v183, v10
    v_min_f32 v183, 0, v183
    v_exp_f32 v183, v183
    v_sub_f32 v184, v184, v10
    v_min_f32 v184, 0, v184
    v_exp_f32 v184, v184
    v_sub_f32 v185, v185, v10
    v_min_f32 v185, 0, v185
    v_exp_f32 v185, v185
    v_sub_f32 v186, v186, v10
    v_min_f32 v186, 0, v186
    v_exp_f32 v186, v186
    v_sub_f32 v187, v187, v10
    v_min_f32 v187, 0, v187
    v_exp_f32 v187, v187
    v_sub_f32 v188, v188, v10
    v_min_f32 v188, 0, v188
    v_exp_f32 v188, v188
    v_sub_f32 v189, v189, v10
    v_min_f32 v189, 0, v189
    v_exp_f32 v189, v189
    v_sub_f32 v190, v190, v10
    v_min_f32 v190, 0, v190
    v_exp_f32 v190, v190
    v_sub_f32 v191, v191, v10
    v_min_f32 v191, 0, v191
    v_exp_f32 v191, v191
    v_cvt_pk_bf16_f32 v208, v176, v177
    v_cvt_pk_bf16_f32 v209, v178, v179
    v_cvt_pk_bf16_f32 v210, v180, v181
    v_cvt_pk_bf16_f32 v211, v182, v183
    v_cvt_pk_bf16_f32 v212, v184, v185
    v_cvt_pk_bf16_f32 v213, v186, v187
    v_cvt_pk_bf16_f32 v214, v188, v189
    v_cvt_pk_bf16_f32 v215, v190, v191
    v_mfma_f32_32x32x16_bf16 v[224:239], v[88:91], v[208:211], v[224:239]
    s_nop 0
    v_mfma_f32_32x32x16_bf16 v[224:239], v[92:95], v[212:215], v[224:239]
    v_mfma_f32_32x32x16_bf16 v[192:207], v[36:39], v[136:139], 0
    s_nop 11
    v_sub_f32 v192, v192, v10
    v_min_f32 v192, 0, v192
    v_exp_f32 v192, v192
    v_sub_f32 v193, v193, v10
    v_min_f32 v193, 0, v193
    v_exp_f32 v193, v193
    v_sub_f32 v194, v194, v10
    v_min_f32 v194, 0, v194
    v_exp_f32 v194, v194
    v_sub_f32 v195, v195, v10
    v_min_f32 v195, 0, v195
    v_exp_f32 v195, v195
    v_sub_f32 v196, v196, v10
    v_min_f32 v196, 0, v196
    v_exp_f32 v196, v196
    v_sub_f32 v197, v197, v10
    v_min_f32 v197, 0, v197
    v_exp_f32 v197, v197
    v_sub_f32 v198, v198, v10
    v_min_f32 v198, 0, v198
    v_exp_f32 v198, v198
    v_sub_f32 v199, v199, v10
    v_min_f32 v199, 0, v199
    v_exp_f32 v199, v199
    v_sub_f32 v200, v200, v10
    v_min_f32 v200, 0, v200
    v_exp_f32 v200, v200
    v_sub_f32 v201, v201, v10
    v_min_f32 v201, 0, v201
    v_exp_f32 v201, v201
    v_sub_f32 v202, v202, v10
    v_min_f32 v202, 0, v202
    v_exp_f32 v202, v202
    v_sub_f32 v203, v203, v10
    v_min_f32 v203, 0, v203
    v_exp_f32 v203, v203
    v_sub_f32 v204, v204, v10
    v_min_f32 v204, 0, v204
    v_exp_f32 v204, v204
    v_sub_f32 v205, v205, v10
    v_min_f32 v205, 0, v205
    v_exp_f32 v205, v205
    v_sub_f32 v206, v206, v10
    v_min_f32 v206, 0, v206
    v_exp_f32 v206, v206
    v_sub_f32 v207, v207, v10
    v_min_f32 v207, 0, v207
    v_exp_f32 v207, v207
    v_cvt_pk_bf16_f32 v216, v192, v193
    v_cvt_pk_bf16_f32 v217, v194, v195
    v_cvt_pk_bf16_f32 v218, v196, v197
    v_cvt_pk_bf16_f32 v219, v198, v199
    v_cvt_pk_bf16_f32 v220, v200, v201
    v_cvt_pk_bf16_f32 v221, v202, v203
    v_cvt_pk_bf16_f32 v222, v204, v205
    v_cvt_pk_bf16_f32 v223, v206, v207
    v_mfma_f32_32x32x16_bf16 v[224:239], v[96:99], v[216:219], v[224:239]
    s_nop 0
    v_mfma_f32_32x32x16_bf16 v[224:239], v[100:103], v[220:223], v[224:239]
    v_mfma_f32_32x32x16_bf16 v[176:191], v[40:43], v[136:139], 0
    s_nop 11
    v_sub_f32 v176, v176, v10
    v_min_f32 v176, 0, v176
    v_exp_f32 v176, v176
    v_sub_f32 v177, v177, v10
    v_min_f32 v177, 0, v177
    v_exp_f32 v177, v177
    v_sub_f32 v178, v178, v10
    v_min_f32 v178, 0, v178
    v_exp_f32 v178, v178
    v_sub_f32 v179, v179, v10
    v_min_f32 v179, 0, v179
    v_exp_f32 v179, v179
    v_sub_f32 v180, v180, v10
    v_min_f32 v180, 0, v180
    v_exp_f32 v180, v180
    v_sub_f32 v181, v181, v10
    v_min_f32 v181, 0, v181
    v_exp_f32 v181, v181
    v_sub_f32 v182, v182, v10
    v_min_f32 v182, 0, v182
    v_exp_f32 v182, v182
    v_sub_f32 v183, v183, v10
    v_min_f32 v183, 0, v183
    v_exp_f32 v183, v183
    v_sub_f32 v184, v184, v10
    v_min_f32 v184, 0, v184
    v_exp_f32 v184, v184
    v_sub_f32 v185, v185, v10
    v_min_f32 v185, 0, v185
    v_exp_f32 v185, v185
    v_sub_f32 v186, v186, v10
    v_min_f32 v186, 0, v186
    v_exp_f32 v186, v186
    v_sub_f32 v187, v187, v10
    v_min_f32 v187, 0, v187
    v_exp_f32 v187, v187
    v_sub_f32 v188, v188, v10
    v_min_f32 v188, 0, v188
    v_exp_f32 v188, v188
    v_sub_f32 v189, v189, v10
    v_min_f32 v189, 0, v189
    v_exp_f32 v189, v189
    v_sub_f32 v190, v190, v10
    v_min_f32 v190, 0, v190
    v_exp_f32 v190, v190
    v_sub_f32 v191, v191, v10
    v_min_f32 v191, 0, v191
    v_exp_f32 v191, v191
    v_cvt_pk_bf16_f32 v208, v176, v177
    v_cvt_pk_bf16_f32 v209, v178, v179
    v_cvt_pk_bf16_f32 v210, v180, v181
    v_cvt_pk_bf16_f32 v211, v182, v183
    v_cvt_pk_bf16_f32 v212, v184, v185
    v_cvt_pk_bf16_f32 v213, v186, v187
    v_cvt_pk_bf16_f32 v214, v188, v189
    v_cvt_pk_bf16_f32 v215, v190, v191
    v_mfma_f32_32x32x16_bf16 v[224:239], v[104:107], v[208:211], v[224:239]
    s_nop 0
    v_mfma_f32_32x32x16_bf16 v[224:239], v[108:111], v[212:215], v[224:239]
    v_mfma_f32_32x32x16_bf16 v[192:207], v[44:47], v[136:139], 0
    s_nop 11
    v_sub_f32 v192, v192, v10
    v_min_f32 v192, 0, v192
    v_exp_f32 v192, v192
    v_sub_f32 v193, v193, v10
    v_min_f32 v193, 0, v193
    v_exp_f32 v193, v193
    v_sub_f32 v194, v194, v10
    v_min_f32 v194, 0, v194
    v_exp_f32 v194, v194
    v_sub_f32 v195, v195, v10
    v_min_f32 v195, 0, v195
    v_exp_f32 v195, v195
    v_sub_f32 v196, v196, v10
    v_min_f32 v196, 0, v196
    v_exp_f32 v196, v196
    v_sub_f32 v197, v197, v10
    v_min_f32 v197, 0, v197
    v_exp_f32 v197, v197
    v_sub_f32 v198, v198, v10
    v_min_f32 v198, 0, v198
    v_exp_f32 v198, v198
    v_sub_f32 v199, v199, v10
    v_min_f32 v199, 0, v199
    v_exp_f32 v199, v199
    v_sub_f32 v200, v200, v10
    v_min_f32 v200, 0, v200
    v_exp_f32 v200, v200
    v_sub_f32 v201, v201, v10
    v_min_f32 v201, 0, v201
    v_exp_f32 v201, v201
    v_sub_f32 v202, v202, v10
    v_min_f32 v202, 0, v202
    v_exp_f32 v202, v202
    v_sub_f32 v203, v203, v10
    v_min_f32 v203, 0, v203
    v_exp_f32 v203, v203
    v_sub_f32 v204, v204, v10
    v_min_f32 v204, 0, v204
    v_exp_f32 v204, v204
    v_sub_f32 v205, v205, v10
    v_min_f32 v205, 0, v205
    v_exp_f32 v205, v205
    v_sub_f32 v206, v206, v10
    v_min_f32 v206, 0, v206
    v_exp_f32 v206, v206
    v_sub_f32 v207, v207, v10
    v_min_f32 v207, 0, v207
    v_exp_f32 v207, v207
    v_cvt_pk_bf16_f32 v216, v192, v193
    v_cvt_pk_bf16_f32 v217, v194, v195
    v_cvt_pk_bf16_f32 v218, v196, v197
    v_cvt_pk_bf16_f32 v219, v198, v199
    v_cvt_pk_bf16_f32 v220, v200, v201
    v_cvt_pk_bf16_f32 v221, v202, v203
    v_cvt_pk_bf16_f32 v222, v204, v205
    v_cvt_pk_bf16_f32 v223, v206, v207
    v_mfma_f32_32x32x16_bf16 v[224:239], v[112:115], v[216:219], v[224:239]
    s_nop 0
    v_mfma_f32_32x32x16_bf16 v[224:239], v[116:119], v[220:223], v[224:239]
    v_mfma_f32_32x32x16_bf16 v[176:191], v[48:51], v[136:139], v[144:159]
    s_nop 11
    v_sub_f32 v176, v176, v10
    v_min_f32 v176, 0, v176
    v_exp_f32 v176, v176
    v_sub_f32 v177, v177, v10
    v_min_f32 v177, 0, v177
    v_exp_f32 v177, v177
    v_sub_f32 v178, v178, v10
    v_min_f32 v178, 0, v178
    v_exp_f32 v178, v178
    v_sub_f32 v179, v179, v10
    v_min_f32 v179, 0, v179
    v_exp_f32 v179, v179
    v_sub_f32 v180, v180, v10
    v_min_f32 v180, 0, v180
    v_exp_f32 v180, v180
    v_sub_f32 v181, v181, v10
    v_min_f32 v181, 0, v181
    v_exp_f32 v181, v181
    v_sub_f32 v182, v182, v10
    v_min_f32 v182, 0, v182
    v_exp_f32 v182, v182
    v_sub_f32 v183, v183, v10
    v_min_f32 v183, 0, v183
    v_exp_f32 v183, v183
    v_sub_f32 v184, v184, v10
    v_min_f32 v184, 0, v184
    v_exp_f32 v184, v184
    v_sub_f32 v185, v185, v10
    v_min_f32 v185, 0, v185
    v_exp_f32 v185, v185
    v_sub_f32 v186, v186, v10
    v_min_f32 v186, 0, v186
    v_exp_f32 v186, v186
    v_sub_f32 v187, v187, v10
    v_min_f32 v187, 0, v187
    v_exp_f32 v187, v187
    v_sub_f32 v188, v188, v10
    v_min_f32 v188, 0, v188
    v_exp_f32 v188, v188
    v_sub_f32 v189, v189, v10
    v_min_f32 v189, 0, v189
    v_exp_f32 v189, v189
    v_sub_f32 v190, v190, v10
    v_min_f32 v190, 0, v190
    v_exp_f32 v190, v190
    v_sub_f32 v191, v191, v10
    v_min_f32 v191, 0, v191
    v_exp_f32 v191, v191
    v_cvt_pk_bf16_f32 v208, v176, v177
    v_cvt_pk_bf16_f32 v209, v178, v179
    v_cvt_pk_bf16_f32 v210, v180, v181
    v_cvt_pk_bf16_f32 v211, v182, v183
    v_cvt_pk_bf16_f32 v212, v184, v185
    v_cvt_pk_bf16_f32 v213, v186, v187
    v_cvt_pk_bf16_f32 v214, v188, v189
    v_cvt_pk_bf16_f32 v215, v190, v191
    v_mfma_f32_32x32x16_bf16 v[224:239], v[120:123], v[208:211], v[224:239]
    s_nop 0
    v_mfma_f32_32x32x16_bf16 v[224:239], v[124:127], v[212:215], v[224:239]
    s_nop 11
    v_rcp_f32 v8, v232
    s_nop 0
    v_mul_f32 v224, v224, v8
    v_mul_f32 v225, v225, v8
    v_mul_f32 v226, v226, v8
    v_mul_f32 v227, v227, v8
    v_mul_f32 v228, v228, v8
    v_mul_f32 v229, v229, v8
    v_mul_f32 v230, v230, v8
    v_mul_f32 v231, v231, v8
    v_cvt_pk_bf16_f32 v232, v224, v225
    v_cvt_pk_bf16_f32 v233, v226, v227
    v_cvt_pk_bf16_f32 v234, v228, v229
    v_cvt_pk_bf16_f32 v235, v230, v231
    s_add_u32 s62, s75, 0
    s_lshl_b32 s62, s62, 5
    s_add_u32 s62, s62, s68
    s_lshl_b32 s62, s62, 10
    s_add_u32 s62, s62, 7340032
    buffer_store_dwordx4 v[232:235], v2, s[32:35], s62 offen sc1
    v_mov_b32 v10, 0xff800000
    s_add_i32 s64, s75, -7
    s_cmp_lt_i32 s64, 0
    s_cbranch_scc1 L_skip_5010
    v_mfma_f32_32x32x16_bf16 v[192:207], v[20:23], v[140:143], v[160:175]
    s_nop 11
    v_max3_f32 v10, v10, v192, v193
    v_max3_f32 v10, v10, v194, v195
    v_max3_f32 v10, v10, v196, v197
    v_max3_f32 v10, v10, v198, v199
    v_max3_f32 v10, v10, v200, v201
    v_max3_f32 v10, v10, v202, v203
    v_max3_f32 v10, v10, v204, v205
    v_max3_f32 v10, v10, v206, v207
L_skip_5010:
    s_nop 7
    s_nop 7
    s_add_i32 s64, s75, -6
    s_cmp_lt_i32 s64, 0
    s_cbranch_scc1 L_skip_5011
    v_mfma_f32_32x32x16_bf16 v[176:191], v[24:27], v[140:143], 0
    s_nop 11
    v_max3_f32 v10, v10, v176, v177
    v_max3_f32 v10, v10, v178, v179
    v_max3_f32 v10, v10, v180, v181
    v_max3_f32 v10, v10, v182, v183
    v_max3_f32 v10, v10, v184, v185
    v_max3_f32 v10, v10, v186, v187
    v_max3_f32 v10, v10, v188, v189
    v_max3_f32 v10, v10, v190, v191
L_skip_5011:
    s_nop 7
    s_nop 7
    s_add_i32 s64, s75, -5
    s_cmp_lt_i32 s64, 0
    s_cbranch_scc1 L_skip_5012
    v_mfma_f32_32x32x16_bf16 v[192:207], v[28:31], v[140:143], 0
    s_nop 11
    v_max3_f32 v10, v10, v192, v193
    v_max3_f32 v10, v10, v194, v195
    v_max3_f32 v10, v10, v196, v197
    v_max3_f32 v10, v10, v198, v199
    v_max3_f32 v10, v10, v200, v201
    v_max3_f32 v10, v10, v202, v203
    v_max3_f32 v10, v10, v204, v205
    v_max3_f32 v10, v10, v206, v207
L_skip_5012:
    s_nop 7
    s_nop 7
    s_add_i32 s64, s75, -4
    s_cmp_lt_i32 s64, 0
    s_cbranch_scc1 L_skip_5013
    v_mfma_f32_32x32x16_bf16 v[176:191], v[32:35], v[140:143], 0
    s_nop 11
    v_max3_f32 v10, v10, v176, v177
    v_max3_f32 v10, v10, v178, v179
    v_max3_f32 v10, v10, v180, v181
    v_max3_f32 v10, v10, v182, v183
    v_max3_f32 v10, v10, v184, v185
    v_max3_f32 v10, v10, v186, v187
    v_max3_f32 v10, v10, v188, v189
    v_max3_f32 v10, v10, v190, v191
L_skip_5013:
    s_nop 7
    s_nop 7
    s_add_i32 s64, s75, -3
    s_cmp_lt_i32 s64, 0
    s_cbranch_scc1 L_skip_5014
    v_mfma_f32_32x32x16_bf16 v[192:207], v[36:39], v[140:143], 0
    s_nop 11
    v_max3_f32 v10, v10, v192, v193
    v_max3_f32 v10, v10, v194, v195
    v_max3_f32 v10, v10, v196, v197
    v_max3_f32 v10, v10, v198, v199
    v_max3_f32 v10, v10, v200, v201
    v_max3_f32 v10, v10, v202, v203
    v_max3_f32 v10, v10, v204, v205
    v_max3_f32 v10, v10, v206, v207
L_skip_5014:
    s_nop 7
    s_nop 7
    s_add_i32 s64, s75, -2
    s_cmp_lt_i32 s64, 0
    s_cbranch_scc1 L_skip_5015
    v_mfma_f32_32x32x16_bf16 v[176:191], v[40:43], v[140:143], 0
    s_nop 11
    v_max3_f32 v10, v10, v176, v177
    v_max3_f32 v10, v10, v178, v179
    v_max3_f32 v10, v10, v180, v181
    v_max3_f32 v10, v10, v182, v183
    v_max3_f32 v10, v10, v184, v185
    v_max3_f32 v10, v10, v186, v187
    v_max3_f32 v10, v10, v188, v189
    v_max3_f32 v10, v10, v190, v191
L_skip_5015:
    s_nop 7
    s_nop 7
    s_add_i32 s64, s75, -1
    s_cmp_lt_i32 s64, 0
    s_cbranch_scc1 L_skip_5016
    v_mfma_f32_32x32x16_bf16 v[192:207], v[44:47], v[140:143], 0
    s_nop 11
    v_max3_f32 v10, v10, v192, v193
    v_max3_f32 v10, v10, v194, v195
    v_max3_f32 v10, v10, v196, v197
    v_max3_f32 v10, v10, v198, v199
    v_max3_f32 v10, v10, v200, v201
    v_max3_f32 v10, v10, v202, v203
    v_max3_f32 v10, v10, v204, v205
    v_max3_f32 v10, v10, v206, v207
L_skip_5016:
    s_nop 7
    s_nop 7
    s_add_i32 s64, s75, 0
    s_cmp_lt_i32 s64, 0
    s_cbranch_scc1 L_skip_5017
    v_mfma_f32_32x32x16_bf16 v[176:191], v[48:51], v[140:143], 0
    s_nop 11
    v_max3_f32 v10, v10, v176, v177
    v_max3_f32 v10, v10, v178, v179
    v_max3_f32 v10, v10, v180, v181
    v_max3_f32 v10, v10, v182, v183
    v_max3_f32 v10, v10, v184, v185
    v_max3_f32 v10, v10, v186, v187
    v_max3_f32 v10, v10, v188, v189
    v_max3_f32 v10, v10, v190, v191
L_skip_5017:
    s_nop 7
    s_nop 7
    s_add_i32 s64, s75, 1
    s_cmp_lt_i32 s64, 0
    s_cbranch_scc1 L_skip_5018
    v_mfma_f32_32x32x16_bf16 v[192:207], v[52:55], v[140:143], v[144:159]
    s_nop 11
    v_max3_f32 v10, v10, v192, v193
    v_max3_f32 v10, v10, v194, v195
    v_max3_f32 v10, v10, v196, v197
    v_max3_f32 v10, v10, v198, v199
    v_max3_f32 v10, v10, v200, v201
    v_max3_f32 v10, v10, v202, v203
    v_max3_f32 v10, v10, v204, v205
    v_max3_f32 v10, v10, v206, v207
L_skip_5018:
    s_nop 7
    s_nop 7
    v_mov_b32 v11, v10
    s_nop 1
    v_permlane32_swap_b32 v10, v11
    v_max_f32 v10, v10, v11
    v_mfma_f32_32x32x16_bf16 v[192:207], v[20:23], v[140:143], v[160:175]
    s_nop 11
    v_sub_f32 v192, v192, v10
    v_min_f32 v192, 0, v192
    v_exp_f32 v192, v192
    v_sub_f32 v193, v193, v10
    v_min_f32 v193, 0, v193
    v_exp_f32 v193, v193
    v_sub_f32 v194, v194, v10
    v_min_f32 v194, 0, v194
    v_exp_f32 v194, v194
    v_sub_f32 v195, v195, v10
    v_min_f32 v195, 0, v195
    v_exp_f32 v195, v195
    v_sub_f32 v196, v196, v10
    v_min_f32 v196, 0, v196
    v_exp_f32 v196, v196
    v_sub_f32 v197, v197, v10
    v_min_f32 v197, 0, v197
    v_exp_f32 v197, v197
    v_sub_f32 v198, v198, v10
    v_min_f32 v198, 0, v198
    v_exp_f32 v198, v198
    v_sub_f32 v199, v199, v10
    v_min_f32 v199, 0, v199
    v_exp_f32 v199, v199
    v_sub_f32 v200, v200, v10
    v_min_f32 v200, 0, v200
    v_exp_f32 v200, v200
    v_sub_f32 v201, v201, v10
    v_min_f32 v201, 0, v201
    v_exp_f32 v201, v201
    v_sub_f32 v202, v202, v10
    v_min_f32 v202, 0, v202
    v_exp_f32 v202, v202
    v_sub_f32 v203, v203, v10
    v_min_f32 v203, 0, v203
    v_exp_f32 v203, v203
    v_sub_f32 v204, v204, v10
    v_min_f32 v204, 0, v204
    v_exp_f32 v204, v204
    v_sub_f32 v205, v205, v10
    v_min_f32 v205, 0, v205
    v_exp_f32 v205, v205
    v_sub_f32 v206, v206, v10
    v_min_f32 v206, 0, v206
    v_exp_f32 v206, v206
    v_sub_f32 v207, v207, v10
    v_min_f32 v207, 0, v207
    v_exp_f32 v207, v207
    v_cvt_pk_bf16_f32 v216, v192, v193
    v_cvt_pk_bf16_f32 v217, v194, v195
    v_cvt_pk_bf16_f32 v218, v196, v197
    v_cvt_pk_bf16_f32 v219, v198, v199
    v_cvt_pk_bf16_f32 v220, v200, v201
    v_cvt_pk_bf16_f32 v221, v202, v203
    v_cvt_pk_bf16_f32 v222, v204, v205
    v_cvt_pk_bf16_f32 v223, v206, v207
    v_mfma_f32_32x32x16_bf16 v[240:255], v[64:67], v[216:219], 0
    s_nop 0
    v_mfma_f32_32x32x16_bf16 v[240:255], v[68:71], v[220:223], v[240:255]
    v_mfma_f32_32x32x16_bf16 v[176:191], v[24:27], v[140:143], 0
    s_nop 11
    v_sub_f32 v176, v176, v10
    v_min_f32 v176, 0, v176
    v_exp_f32 v176, v176
    v_sub_f32 v177, v177, v10
    v_min_f32 v177, 0, v177
    v_exp_f32 v177, v177
    v_sub_f32 v178, v178, v10
    v_min_f32 v178, 0, v178
    v_exp_f32 v178, v178
    v_sub_f32 v179, v179, v10
    v_min_f32 v179, 0, v179
    v_exp_f32 v179, v179
    v_sub_f32 v180, v180, v10
    v_min_f32 v180, 0, v180
    v_exp_f32 v180, v180
    v_sub_f32 v181, v181, v10
    v_min_f32 v181, 0, v181
    v_exp_f32 v181, v181
    v_sub_f32 v182, v182, v10
    v_min_f32 v182, 0, v182
    v_exp_f32 v182, v182
    v_sub_f32 v183, v183, v10
    v_min_f32 v183, 0, v183
    v_exp_f32 v183, v183
    v_sub_f32 v184, v184, v10
    v_min_f32 v184, 0, v184
    v_exp_f32 v184, v184
    v_sub_f32 v185, v185, v10
    v_min_f32 v185, 0, v185
    v_exp_f32 v185, v185
    v_sub_f32 v186, v186, v10
    v_min_f32 v186, 0, v186
    v_exp_f32 v186, v186
    v_sub_f32 v187, v187, v10
    v_min_f32 v187, 0, v187
    v_exp_f32 v187, v187
    v_sub_f32 v188, v188, v10
    v_min_f32 v188, 0, v188
    v_exp_f32 v188, v188
    v_sub_f32 v189, v189, v10
    v_min_f32 v189, 0, v189
    v_exp_f32 v189, v189
    v_sub_f32 v190, v190, v10
    v_min_f32 v190, 0, v190
    v_exp_f32 v190, v190
    v_sub_f32 v191, v191, v10
    v_min_f32 v191, 0, v191
    v_exp_f32 v191, v191
    v_cvt_pk_bf16_f32 v208, v176, v177
    v_cvt_pk_bf16_f32 v209, v178, v179
    v_cvt_pk_bf16_f32 v210, v180, v181
    v_cvt_pk_bf16_f32 v211, v182, v183
    v_cvt_pk_bf16_f32 v212, v184, v185
    v_cvt_pk_bf16_f32 v213, v186, v187
    v_cvt_pk_bf16_f32 v214, v188, v189
    v_cvt_pk_bf16_f32 v215, v190, v191
    v_mfma_f32_32x32x16_bf16 v[240:255], v[72:75], v[208:211], v[240:255]
    s_nop 0
    v_mfma_f32_32x32x16_bf16 v[240:255], v[76:79], v[212:215], v[240:255]
    v_mfma_f32_32x32x16_bf16 v[192:207], v[28:31], v[140:143], 0
    s_nop 11
    v_sub_f32 v192, v192, v10
    v_min_f32 v192, 0, v192
    v_exp_f32 v192, v192
    v_sub_f32 v193, v193, v10
    v_min_f32 v193, 0, v193
    v_exp_f32 v193, v193
    v_sub_f32 v194, v194, v10
    v_min_f32 v194, 0, v194
    v_exp_f32 v194, v194
    v_sub_f32 v195, v195, v10
    v_min_f32 v195, 0, v195
    v_exp_f32 v195, v195
    v_sub_f32 v196, v196, v10
    v_min_f32 v196, 0, v196
    v_exp_f32 v196, v196
    v_sub_f32 v197, v197, v10
    v_min_f32 v197, 0, v197
    v_exp_f32 v197, v197
    v_sub_f32 v198, v198, v10
    v_min_f32 v198, 0, v198
    v_exp_f32 v198, v198
    v_sub_f32 v199, v199, v10
    v_min_f32 v199, 0, v199
    v_exp_f32 v199, v199
    v_sub_f32 v200, v200, v10
    v_min_f32 v200, 0, v200
    v_exp_f32 v200, v200
    v_sub_f32 v201, v201, v10
    v_min_f32 v201, 0, v201
    v_exp_f32 v201, v201
    v_sub_f32 v202, v202, v10
    v_min_f32 v202, 0, v202
    v_exp_f32 v202, v202
    v_sub_f32 v203, v203, v10
    v_min_f32 v203, 0, v203
    v_exp_f32 v203, v203
    v_sub_f32 v204, v204, v10
    v_min_f32 v204, 0, v204
    v_exp_f32 v204, v204
    v_sub_f32 v205, v205, v10
    v_min_f32 v205, 0, v205
    v_exp_f32 v205, v205
    v_sub_f32 v206, v206, v10
    v_min_f32 v206, 0, v206
    v_exp_f32 v206, v206
    v_sub_f32 v207, v207, v10
    v_min_f32 v207, 0, v207
    v_exp_f32 v207, v207
    v_cvt_pk_bf16_f32 v216, v192, v193
    v_cvt_pk_bf16_f32 v217, v194, v195
    v_cvt_pk_bf16_f32 v218, v196, v197
    v_cvt_pk_bf16_f32 v219, v198, v199
    v_cvt_pk_bf16_f32 v220, v200, v201
    v_cvt_pk_bf16_f32 v221, v202, v203
    v_cvt_pk_bf16_f32 v222, v204, v205
    v_cvt_pk_bf16_f32 v223, v206, v207
    v_mfma_f32_32x32x16_bf16 v[240:255], v[80:83], v[216:219], v[240:255]
    s_nop 0
    v_mfma_f32_32x32x16_bf16 v[240:255], v[84:87], v[220:223], v[240:255]
    v_mfma_f32_32x32x16_bf16 v[176:191], v[32:35], v[140:143], 0
    s_nop 11
    v_sub_f32 v176, v176, v10
    v_min_f32 v176, 0, v176
    v_exp_f32 v176, v176
    v_sub_f32 v177, v177, v10
    v_min_f32 v177, 0, v177
    v_exp_f32 v177, v177
    v_sub_f32 v178, v178, v10
    v_min_f32 v178, 0, v178
    v_exp_f32 v178, v178
    v_sub_f32 v179, v179, v10
    v_min_f32 v179, 0, v179
    v_exp_f32 v179, v179
    v_sub_f32 v180, v180, v10
    v_min_f32 v180, 0, v180
    v_exp_f32 v180, v180
    v_sub_f32 v181, v181, v10
    v_min_f32 v181, 0, v181
    v_exp_f32 v181, v181
    v_sub_f32 v182, v182, v10
    v_min_f32 v182, 0, v182
    v_exp_f32 v182, v182
    v_sub_f32 v183, v183, v10
    v_min_f32 v183, 0, v183
    v_exp_f32 v183, v183
    v_sub_f32 v184, v184, v10
    v_min_f32 v184, 0, v184
    v_exp_f32 v184, v184
    v_sub_f32 v185, v185, v10
    v_min_f32 v185, 0, v185
    v_exp_f32 v185, v185
    v_sub_f32 v186, v186, v10
    v_min_f32 v186, 0, v186
    v_exp_f32 v186, v186
    v_sub_f32 v187, v187, v10
    v_min_f32 v187, 0, v187
    v_exp_f32 v187, v187
    v_sub_f32 v188, v188, v10
    v_min_f32 v188, 0, v188
    v_exp_f32 v188, v188
    v_sub_f32 v189, v189, v10
    v_min_f32 v189, 0, v189
    v_exp_f32 v189, v189
    v_sub_f32 v190, v190, v10
    v_min_f32 v190, 0, v190
    v_exp_f32 v190, v190
    v_sub_f32 v191, v191, v10
    v_min_f32 v191, 0, v191
    v_exp_f32 v191, v191
    v_cvt_pk_bf16_f32 v208, v176, v177
    v_cvt_pk_bf16_f32 v209, v178, v179
    v_cvt_pk_bf16_f32 v210, v180, v181
    v_cvt_pk_bf16_f32 v211, v182, v183
    v_cvt_pk_bf16_f32 v212, v184, v185
    v_cvt_pk_bf16_f32 v213, v186, v187
    v_cvt_pk_bf16_f32 v214, v188, v189
    v_cvt_pk_bf16_f32 v215, v190, v191
    v_mfma_f32_32x32x16_bf16 v[240:255], v[88:91], v[208:211], v[240:255]
    s_nop 0
    v_mfma_f32_32x32x16_bf16 v[240:255], v[92:95], v[212:215], v[240:255]
    v_mfma_f32_32x32x16_bf16 v[192:207], v[36:39], v[140:143], 0
    s_nop 11
    v_sub_f32 v192, v192, v10
    v_min_f32 v192, 0, v192
    v_exp_f32 v192, v192
    v_sub_f32 v193, v193, v10
    v_min_f32 v193, 0, v193
    v_exp_f32 v193, v193
    v_sub_f32 v194, v194, v10
    v_min_f32 v194, 0, v194
    v_exp_f32 v194, v194
    v_sub_f32 v195, v195, v10
    v_min_f32 v195, 0, v195
    v_exp_f32 v195, v195
    v_sub_f32 v196, v196, v10
    v_min_f32 v196, 0, v196
    v_exp_f32 v196, v196
    v_sub_f32 v197, v197, v10
    v_min_f32 v197, 0, v197
    v_exp_f32 v197, v197
    v_sub_f32 v198, v198, v10
    v_min_f32 v198, 0, v198
    v_exp_f32 v198, v198
    v_sub_f32 v199, v199, v10
    v_min_f32 v199, 0, v199
    v_exp_f32 v199, v199
    v_sub_f32 v200, v200, v10
    v_min_f32 v200, 0, v200
    v_exp_f32 v200, v200
    v_sub_f32 v201, v201, v10
    v_min_f32 v201, 0, v201
    v_exp_f32 v201, v201
    v_sub_f32 v202, v202, v10
    v_min_f32 v202, 0, v202
    v_exp_f32 v202, v202
    v_sub_f32 v203, v203, v10
    v_min_f32 v203, 0, v203
    v_exp_f32 v203, v203
    v_sub_f32 v204, v204, v10
    v_min_f32 v204, 0, v204
    v_exp_f32 v204, v204
    v_sub_f32 v205, v205, v10
    v_min_f32 v205, 0, v205
    v_exp_f32 v205, v205
    v_sub_f32 v206, v206, v10
    v_min_f32 v206, 0, v206
    v_exp_f32 v206, v206
    v_sub_f32 v207, v207, v10
    v_min_f32 v207, 0, v207
    v_exp_f32 v207, v207
    v_cvt_pk_bf16_f32 v216, v192, v193
    v_cvt_pk_bf16_f32 v217, v194, v195
    v_cvt_pk_bf16_f32 v218, v196, v197
    v_cvt_pk_bf16_f32 v219, v198, v199
    v_cvt_pk_bf16_f32 v220, v200, v201
    v_cvt_pk_bf16_f32 v221, v202, v203
    v_cvt_pk_bf16_f32 v222, v204, v205
    v_cvt_pk_bf16_f32 v223, v206, v207
    v_mfma_f32_32x32x16_bf16 v[240:255], v[96:99], v[216:219], v[240:255]
    s_nop 0
    v_mfma_f32_32x32x16_bf16 v[240:255], v[100:103], v[220:223], v[240:255]
    v_mfma_f32_32x32x16_bf16 v[176:191], v[40:43], v[140:143], 0
    s_nop 11
    v_sub_f32 v176, v176, v10
    v_min_f32 v176, 0, v176
    v_exp_f32 v176, v176
    v_sub_f32 v177, v177, v10
    v_min_f32 v177, 0, v177
    v_exp_f32 v177, v177
    v_sub_f32 v178, v178, v10
    v_min_f32 v178, 0, v178
    v_exp_f32 v178, v178
    v_sub_f32 v179, v179, v10
    v_min_f32 v179, 0, v179
    v_exp_f32 v179, v179
    v_sub_f32 v180, v180, v10
    v_min_f32 v180, 0, v180
    v_exp_f32 v180, v180
    v_sub_f32 v181, v181, v10
    v_min_f32 v181, 0, v181
    v_exp_f32 v181, v181
    v_sub_f32 v182, v182, v10
    v_min_f32 v182, 0, v182
    v_exp_f32 v182, v182
    v_sub_f32 v183, v183, v10
    v_min_f32 v183, 0, v183
    v_exp_f32 v183, v183
    v_sub_f32 v184, v184, v10
    v_min_f32 v184, 0, v184
    v_exp_f32 v184, v184
    v_sub_f32 v185, v185, v10
    v_min_f32 v185, 0, v185
    v_exp_f32 v185, v185
    v_sub_f32 v186, v186, v10
    v_min_f32 v186, 0, v186
    v_exp_f32 v186, v186
    v_sub_f32 v187, v187, v10
    v_min_f32 v187, 0, v187
    v_exp_f32 v187, v187
    v_sub_f32 v188, v188, v10
    v_min_f32 v188, 0, v188
    v_exp_f32 v188, v188
    v_sub_f32 v189, v189, v10
    v_min_f32 v189, 0, v189
    v_exp_f32 v189, v189
    v_sub_f32 v190, v190, v10
    v_min_f32 v190, 0, v190
    v_exp_f32 v190, v190
    v_sub_f32 v191, v191, v10
    v_min_f32 v191, 0, v191
    v_exp_f32 v191, v191
    v_cvt_pk_bf16_f32 v208, v176, v177
    v_cvt_pk_bf16_f32 v209, v178, v179
    v_cvt_pk_bf16_f32 v210, v180, v181
    v_cvt_pk_bf16_f32 v211, v182, v183
    v_cvt_pk_bf16_f32 v212, v184, v185
    v_cvt_pk_bf16_f32 v213, v186, v187
    v_cvt_pk_bf16_f32 v214, v188, v189
    v_cvt_pk_bf16_f32 v215, v190, v191
    v_mfma_f32_32x32x16_bf16 v[240:255], v[104:107], v[208:211], v[240:255]
    s_nop 0
    v_mfma_f32_32x32x16_bf16 v[240:255], v[108:111], v[212:215], v[240:255]
    v_mfma_f32_32x32x16_bf16 v[192:207], v[44:47], v[140:143], 0
    s_nop 11
    v_sub_f32 v192, v192, v10
    v_min_f32 v192, 0, v192
    v_exp_f32 v192, v192
    v_sub_f32 v193, v193, v10
    v_min_f32 v193, 0, v193
    v_exp_f32 v193, v193
    v_sub_f32 v194, v194, v10
    v_min_f32 v194, 0, v194
    v_exp_f32 v194, v194
    v_sub_f32 v195, v195, v10
    v_min_f32 v195, 0, v195
    v_exp_f32 v195, v195
    v_sub_f32 v196, v196, v10
    v_min_f32 v196, 0, v196
    v_exp_f32 v196, v196
    v_sub_f32 v197, v197, v10
    v_min_f32 v197, 0, v197
    v_exp_f32 v197, v197
    v_sub_f32 v198, v198, v10
    v_min_f32 v198, 0, v198
    v_exp_f32 v198, v198
    v_sub_f32 v199, v199, v10
    v_min_f32 v199, 0, v199
    v_exp_f32 v199, v199
    v_sub_f32 v200, v200, v10
    v_min_f32 v200, 0, v200
    v_exp_f32 v200, v200
    v_sub_f32 v201, v201, v10
    v_min_f32 v201, 0, v201
    v_exp_f32 v201, v201
    v_sub_f32 v202, v202, v10
    v_min_f32 v202, 0, v202
    v_exp_f32 v202, v202
    v_sub_f32 v203, v203, v10
    v_min_f32 v203, 0, v203
    v_exp_f32 v203, v203
    v_sub_f32 v204, v204, v10
    v_min_f32 v204, 0, v204
    v_exp_f32 v204, v204
    v_sub_f32 v205, v205, v10
    v_min_f32 v205, 0, v205
    v_exp_f32 v205, v205
    v_sub_f32 v206, v206, v10
    v_min_f32 v206, 0, v206
    v_exp_f32 v206, v206
    v_sub_f32 v207, v207, v10
    v_min_f32 v207, 0, v207
    v_exp_f32 v207, v207
    v_cvt_pk_bf16_f32 v216, v192, v193
    v_cvt_pk_bf16_f32 v217, v194, v195
    v_cvt_pk_bf16_f32 v218, v196, v197
    v_cvt_pk_bf16_f32 v219, v198, v199
    v_cvt_pk_bf16_f32 v220, v200, v201
    v_cvt_pk_bf16_f32 v221, v202, v203
    v_cvt_pk_bf16_f32 v222, v204, v205
    v_cvt_pk_bf16_f32 v223, v206, v207
    v_mfma_f32_32x32x16_bf16 v[240:255], v[112:115], v[216:219], v[240:255]
    s_nop 0
    v_mfma_f32_32x32x16_bf16 v[240:255], v[116:119], v[220:223], v[240:255]
    v_mfma_f32_32x32x16_bf16 v[176:191], v[48:51], v[140:143], 0
    s_nop 11
    v_sub_f32 v176, v176, v10
    v_min_f32 v176, 0, v176
    v_exp_f32 v176, v176
    v_sub_f32 v177, v177, v10
    v_min_f32 v177, 0, v177
    v_exp_f32 v177, v177
    v_sub_f32 v178, v178, v10
    v_min_f32 v178, 0, v178
    v_exp_f32 v178, v178
    v_sub_f32 v179, v179, v10
    v_min_f32 v179, 0, v179
    v_exp_f32 v179, v179
    v_sub_f32 v180, v180, v10
    v_min_f32 v180, 0, v180
    v_exp_f32 v180, v180
    v_sub_f32 v181, v181, v10
    v_min_f32 v181, 0, v181
    v_exp_f32 v181, v181
    v_sub_f32 v182, v182, v10
    v_min_f32 v182, 0, v182
    v_exp_f32 v182, v182
    v_sub_f32 v183, v183, v10
    v_min_f32 v183, 0, v183
    v_exp_f32 v183, v183
    v_sub_f32 v184, v184, v10
    v_min_f32 v184, 0, v184
    v_exp_f32 v184, v184
    v_sub_f32 v185, v185, v10
    v_min_f32 v185, 0, v185
    v_exp_f32 v185, v185
    v_sub_f32 v186, v186, v10
    v_min_f32 v186, 0, v186
    v_exp_f32 v186, v186
    v_sub_f32 v187, v187, v10
    v_min_f32 v187, 0, v187
    v_exp_f32 v187, v187
    v_sub_f32 v188, v188, v10
    v_min_f32 v188, 0, v188
    v_exp_f32 v188, v188
    v_sub_f32 v189, v189, v10
    v_min_f32 v189, 0, v189
    v_exp_f32 v189, v189
    v_sub_f32 v190, v190, v10
    v_min_f32 v190, 0, v190
    v_exp_f32 v190, v190
    v_sub_f32 v191, v191, v10
    v_min_f32 v191, 0, v191
    v_exp_f32 v191, v191
    v_cvt_pk_bf16_f32 v208, v176, v177
    v_cvt_pk_bf16_f32 v209, v178, v179
    v_cvt_pk_bf16_f32 v210, v180, v181
    v_cvt_pk_bf16_f32 v211, v182, v183
    v_cvt_pk_bf16_f32 v212, v184, v185
    v_cvt_pk_bf16_f32 v213, v186, v187
    v_cvt_pk_bf16_f32 v214, v188, v189
    v_cvt_pk_bf16_f32 v215, v190, v191
    v_mfma_f32_32x32x16_bf16 v[240:255], v[120:123], v[208:211], v[240:255]
    s_nop 0
    v_mfma_f32_32x32x16_bf16 v[240:255], v[124:127], v[212:215], v[240:255]
    v_mfma_f32_32x32x16_bf16 v[192:207], v[52:55], v[140:143], v[144:159]
    s_nop 11
    v_sub_f32 v192, v192, v10
    v_min_f32 v192, 0, v192
    v_exp_f32 v192, v192
    v_sub_f32 v193, v193, v10
    v_min_f32 v193, 0, v193
    v_exp_f32 v193, v193
    v_sub_f32 v194, v194, v10
    v_min_f32 v194, 0, v194
    v_exp_f32 v194, v194
    v_sub_f32 v195, v195, v10
    v_min_f32 v195, 0, v195
    v_exp_f32 v195, v195
    v_sub_f32 v196, v196, v10
    v_min_f32 v196, 0, v196
    v_exp_f32 v196, v196
    v_sub_f32 v197, v197, v10
    v_min_f32 v197, 0, v197
    v_exp_f32 v197, v197
    v_sub_f32 v198, v198, v10
    v_min_f32 v198, 0, v198
    v_exp_f32 v198, v198
    v_sub_f32 v199, v199, v10
    v_min_f32 v199, 0, v199
    v_exp_f32 v199, v199
    v_sub_f32 v200, v200, v10
    v_min_f32 v200, 0, v200
    v_exp_f32 v200, v200
    v_sub_f32 v201, v201, v10
    v_min_f32 v201, 0, v201
    v_exp_f32 v201, v201
    v_sub_f32 v202, v202, v10
    v_min_f32 v202, 0, v202
    v_exp_f32 v202, v202
    v_sub_f32 v203, v203, v10
    v_min_f32 v203, 0, v203
    v_exp_f32 v203, v203
    v_sub_f32 v204, v204, v10
    v_min_f32 v204, 0, v204
    v_exp_f32 v204, v204
    v_sub_f32 v205, v205, v10
    v_min_f32 v205, 0, v205
    v_exp_f32 v205, v205
    v_sub_f32 v206, v206, v10
    v_min_f32 v206, 0, v206
    v_exp_f32 v206, v206
    v_sub_f32 v207, v207, v10
    v_min_f32 v207, 0, v207
    v_exp_f32 v207, v207
    v_cvt_pk_bf16_f32 v216, v192, v193
    v_cvt_pk_bf16_f32 v217, v194, v195
    v_cvt_pk_bf16_f32 v218, v196, v197
    v_cvt_pk_bf16_f32 v219, v198, v199
    v_cvt_pk_bf16_f32 v220, v200, v201
    v_cvt_pk_bf16_f32 v221, v202, v203
    v_cvt_pk_bf16_f32 v222, v204, v205
    v_cvt_pk_bf16_f32 v223, v206, v207
    v_mfma_f32_32x32x16_bf16 v[240:255], v[128:131], v[216:219], v[240:255]
    s_nop 0
    v_mfma_f32_32x32x16_bf16 v[240:255], v[132:135], v[220:223], v[240:255]
    s_nop 11
    v_rcp_f32 v8, v248
    s_nop 0
    v_mul_f32 v240, v240, v8
    v_mul_f32 v241, v241, v8
    v_mul_f32 v242, v242, v8
    v_mul_f32 v243, v243, v8
    v_mul_f32 v244, v244, v8
    v_mul_f32 v245, v245, v8
    v_mul_f32 v246, v246, v8
    v_mul_f32 v247, v247, v8
    v_cvt_pk_bf16_f32 v248, v240, v241
    v_cvt_pk_bf16_f32 v249, v242, v243
    v_cvt_pk_bf16_f32 v250, v244, v245
    v_cvt_pk_bf16_f32 v251, v246, v247
    s_add_u32 s62, s75, 1
    s_lshl_b32 s62, s62, 5
    s_add_u32 s62, s62, s68
    s_lshl_b32 s62, s62, 10
    s_add_u32 s62, s62, 7340032
    buffer_store_dwordx4 v[248:251], v2, s[32:35], s62 offen sc1
    s_branch L_attn_done
L_end:
    s_endpgm
.section .rodata,"a"
.p2align 6
.amdhsa_kernel parallel_sum__sliding_block__mixer_channel_mlp__prompt_kernel
  .amdhsa_next_free_vgpr 256
  .amdhsa_next_free_sgpr 102
  .amdhsa_accum_offset 256
  .amdhsa_group_segment_fixed_size 0
  .amdhsa_kernarg_size 88
  .amdhsa_user_sgpr_count 2
  .amdhsa_user_sgpr_kernarg_segment_ptr 1
  .amdhsa_system_sgpr_workgroup_id_x 1
  .amdhsa_float_denorm_mode_32 3
.end_amdhsa_kernel
```
